```python
import torch

def _softmax(x, axis=-1):
    return torch.softmax(x, dim=axis)
def _gelu(x):
    return torch.nn.functional.gelu(x, approximate="tanh")
def _silu(x):
    return torch.nn.functional.silu(x)
def _sigmoid(x):
    return torch.sigmoid(x)
def _layernorm(x, axis=-1, eps=1e-5):
    m = x.mean(dim=axis, keepdim=True)
    v = x.var(dim=axis, keepdim=True, unbiased=False)
    return (x - m) / torch.sqrt(v + eps)
def _scatter_add(tgt, idx, src, axis=0):
    return tgt.clone().index_add_(axis, idx, src)
def _segment_sum(src, seg, n):
    out = torch.zeros((n,) + src.shape[1:], dtype=src.dtype)
    return out.index_add_(0, seg, src)
def _pad(x, pw):
    flat = tuple(v for pair in reversed(pw) for v in pair)
    return torch.nn.functional.pad(x, flat)

kernel_name = 'recurrent_scan__compressed_kv_cla__geglu_ffn__decode'

def setup_inputs():

    _w = (lambda a: (lambda t: t.to(torch.bfloat16) if t.is_floating_point() else t)(torch.as_tensor(a)))
    def _A_setup():
        B, H, Sq, Sk, D, M = 2, 32, 1, 8192, 128, 640
        Dc = 4 * D
        return {
            "x": _w((lambda *s: torch.randn(*s, dtype=torch.bfloat16) * 0.05)(B, Sq, M)),
            "c_kv": _w((lambda *s: torch.randn(*s, dtype=torch.bfloat16) * 0.8)(B, Sk, Dc)),
            "w_q": _w((lambda *s: torch.randn(*s, dtype=torch.bfloat16) * 1.6)(M, H, D) * (M ** -0.5)),
            "w_uk": _w((lambda *s: torch.randn(*s, dtype=torch.bfloat16) * 1.6)(Dc, H, D) * (Dc ** -0.5)),
            "w_uv": _w((lambda *s: torch.randn(*s, dtype=torch.bfloat16) * 0.8)(Dc, H, D) * (Dc ** -0.5)),
            "w_o": _w((lambda *s: torch.randn(*s, dtype=torch.bfloat16) * 0.8)(H, D, M) * ((H * D) ** -0.5)),
        }
    _A_in = _A_setup()

    def _B_setup():
        B, S, D, F = 2, 1, 640, 1728
        return {
            "x": _w((lambda *s: torch.randn(*s, dtype=torch.bfloat16) * 0.05)(B, S, D)),
            "w_gate": _w((lambda *s: torch.randn(*s, dtype=torch.bfloat16) * 0.2)(D, F)),
            "w_up": _w((lambda *s: torch.randn(*s, dtype=torch.bfloat16) * 0.2)(D, F)),
            "w_down": _w((lambda *s: torch.randn(*s, dtype=torch.bfloat16) * 0.2)(F, D)),
        }
    _B_in = _B_setup()

    return {
        "A_x": _A_in["x"],
        "A_c_kv": _A_in["c_kv"],
        "A_w_q": _A_in["w_q"],
        "A_w_uk": _A_in["w_uk"],
        "A_w_uv": _A_in["w_uv"],
        "A_w_o": _A_in["w_o"],
        "B_x": _B_in["x"],
        "B_w_gate": _B_in["w_gate"],
        "B_w_up": _B_in["w_up"],
        "B_w_down": _B_in["w_down"],
    }

def reference(A_x, A_c_kv, A_w_q, A_w_uk, A_w_uv, A_w_o, B_x, B_w_gate, B_w_up, B_w_down):
    def _A_ref(x, c_kv, w_q, w_uk, w_uv, w_o):
        B, Sq, M = x.shape[0], x.shape[1], x.shape[2]
        Sk = c_kv.shape[1]
        H, D = w_q.shape[1], w_q.shape[2]
        q = torch.einsum("bqm,mhd->bhqd", x, w_q)
        k = torch.einsum("bkc,chd->bhkd", c_kv, w_uk)
        v = torch.einsum("bkc,chd->bhkd", c_kv, w_uv)
        scores = torch.einsum("bhqd,bhkd->bhqk", q, k) * (D ** -0.5)
        off = Sk - Sq
        qi = torch.arange(Sq)[:, None]
        kj = torch.arange(Sk)[None, :]
        cmask = kj <= (qi + off)
        scores = torch.where(cmask[None, None], scores, -1e9)
        p = _softmax(scores, axis=-1)
        ctx = torch.einsum("bhqk,bhkd->bhqd", p, v)
        return torch.einsum("bhqd,hdm->bqm", ctx, w_o)

    def _B_ref(x, w_gate, w_up, w_down):
        return (_gelu(x @ w_gate) * (x @ w_up)) @ w_down

    x = A_x
    xn = _layernorm(x, axis=-1)
    s = _A_ref(xn, A_c_kv, A_w_q, A_w_uk, A_w_uv, A_w_o)
    g = _silu(_B_ref(xn, B_w_gate, B_w_up, B_w_down))
    return x + s * g
```

```asm
; @launch grid=(256,1,1) block=(512,1,1) lds=163840
.amdgcn_target "amdgcn-amd-amdhsa--gfx950"
.text
.globl recurrent_scan__compressed_kv_cla__geglu_ffn__decode_kernel
.p2align 8
.type recurrent_scan__compressed_kv_cla__geglu_ffn__decode_kernel,@function
recurrent_scan__compressed_kv_cla__geglu_ffn__decode_kernel:
L_codestart:
    s_getpc_b64 s[38:39]
    s_cmp_ge_u32 s2, 256
    s_cbranch_scc1 L_exit
    s_load_dwordx16 s[4:19], s[0:1], 0
    s_load_dwordx2 s[28:29], s[0:1], 96
    s_load_dwordx8 s[20:27], s[0:1], 64
    v_lshrrev_b32 v4, 6, v0
    v_and_b32 v1, 63, v0
    v_readfirstlane_b32 s3, v4
    s_and_b32 s69, s2, 7
    s_lshr_b32 s53, s2, 3
    s_and_b32 s54, s53, 3
    s_lshl_b32 s54, s54, 3
    s_add_u32 s31, s54, s69
    s_lshr_b32 s32, s53, 2
    s_add_u32 s54, s54, s3
    s_lshl_b32 s54, s54, 9
    v_lshl_add_u32 v4, v1, 7, s54
    v_min_u32 v4, L_codeend-L_codestart-8, v4
    s_mov_b64 exec, 15
    global_load_dword v255, v4, s[38:39]
    s_mov_b64 exec, -1
    s_cmp_eq_u32 s3, 7
    s_cbranch_scc0 L_pro1
    v_and_b32 v6, 3, v1
    v_lshrrev_b32 v7, 3, v1
    v_lshl_add_u32 v10, v7, 2, v6
    v_bfe_u32 v7, v1, 2, 1
    v_mul_u32_u24 v7, 1280, v7
    v_mad_u32_u24 v6, v10, 40, v7
    v_lshl_add_u32 v7, v10, 2, v7
    s_mul_i32 s55, s32, 160
    s_mov_b32 s50, 2560
    s_mov_b32 s51, 0x00020000
    s_waitcnt lgkmcnt(0)
    s_mov_b64 s[48:49], s[4:5]
    buffer_load_dwordx4 v[12:15], v6, s[48:51], 0 offen
    buffer_load_dwordx4 v[16:19], v6, s[48:51], 0 offen offset:16
    buffer_load_dwordx2 v[20:21], v6, s[48:51], 0 offen offset:32
    buffer_load_dword v22, v7, s[48:51], s55 offen
    buffer_load_dword v23, v7, s[48:51], s55 offen offset:128
L_pro1:
    s_cmp_eq_u32 s3, 4
    s_cbranch_scc0 L_pro2
    v_lshrrev_b32 v4, 4, v1
    v_mul_u32_u24 v4, 163840, v4
    v_and_b32 v5, 15, v1
    v_lshl_add_u32 v4, v5, 4, v4
    s_mul_i32 s52, s32, 655360
    s_lshl_b32 s54, s31, 8
    s_add_u32 s52, s52, s54
    s_mov_b32 s46, 5242880
    s_mov_b32 s47, 0x00020000
    s_movk_i32 s54, 8192
    s_waitcnt lgkmcnt(0)
    s_mov_b64 s[44:45], s[8:9]
    buffer_load_dwordx4 v[36:39], v4, s[44:47], s52 offen nt
    s_add_u32 s52, s52, s54
    buffer_load_dwordx4 v[40:43], v4, s[44:47], s52 offen nt
    s_add_u32 s52, s52, s54
    buffer_load_dwordx4 v[44:47], v4, s[44:47], s52 offen nt
    s_add_u32 s52, s52, s54
    buffer_load_dwordx4 v[48:51], v4, s[44:47], s52 offen nt
    s_add_u32 s52, s52, s54
    buffer_load_dwordx4 v[52:55], v4, s[44:47], s52 offen nt
    s_add_u32 s52, s52, s54
    buffer_load_dwordx4 v[56:59], v4, s[44:47], s52 offen nt
    s_add_u32 s52, s52, s54
    buffer_load_dwordx4 v[60:63], v4, s[44:47], s52 offen nt
    s_add_u32 s52, s52, s54
    buffer_load_dwordx4 v[64:67], v4, s[44:47], s52 offen nt
    s_add_u32 s52, s52, s54
    buffer_load_dwordx4 v[68:71], v4, s[44:47], s52 offen nt
    s_add_u32 s52, s52, s54
    buffer_load_dwordx4 v[72:75], v4, s[44:47], s52 offen nt
    s_add_u32 s52, s52, s54
    buffer_load_dwordx4 v[76:79], v4, s[44:47], s52 offen nt
    s_add_u32 s52, s52, s54
    buffer_load_dwordx4 v[80:83], v4, s[44:47], s52 offen nt
    s_add_u32 s52, s52, s54
    buffer_load_dwordx4 v[84:87], v4, s[44:47], s52 offen nt
    s_add_u32 s52, s52, s54
    buffer_load_dwordx4 v[88:91], v4, s[44:47], s52 offen nt
    s_add_u32 s52, s52, s54
    buffer_load_dwordx4 v[92:95], v4, s[44:47], s52 offen nt
    s_add_u32 s52, s52, s54
    buffer_load_dwordx4 v[96:99], v4, s[44:47], s52 offen nt
    s_add_u32 s52, s52, s54
    buffer_load_dwordx4 v[100:103], v4, s[44:47], s52 offen nt
    s_add_u32 s52, s52, s54
    buffer_load_dwordx4 v[104:107], v4, s[44:47], s52 offen nt
    s_add_u32 s52, s52, s54
    buffer_load_dwordx4 v[108:111], v4, s[44:47], s52 offen nt
    s_add_u32 s52, s52, s54
    buffer_load_dwordx4 v[112:115], v4, s[44:47], s52 offen nt
L_pro2:
    v_mov_b32 v11, 0
    v_lshlrev_b32 v2, 4, v1
    s_and_b32 s34, s53, 1
    s_lshr_b32 s54, s53, 1
    s_lshl_b32 s55, s69, 4
    s_add_u32 s33, s54, s55
    s_lshr_b32 s35, s33, 6
    s_lshl_b32 s54, s31, 3
    s_add_u32 s36, s54, s32
    s_mov_b32 s60, 0
    s_mov_b32 s61, -1
    s_mov_b32 s62, 0x05040100
    s_mov_b32 s63, 0x07060302
    s_mov_b32 s64, 0xffffff00
    s_mov_b32 s65, 0xffff0000
    v_lshlrev_b32 v4, 2, v1
    ds_write_b32 v4, v11 offset:4352
    v_mov_b32 v5, 0xff800000
    ds_write_b32 v4, v5 offset:4096
    s_waitcnt lgkmcnt(0)
    s_load_dword s30, s[28:29], 0
    s_mov_b32 s40, s28
    s_mov_b32 s41, s29
    s_mov_b32 s42, 8388608
    s_mov_b32 s43, 0x00020000
    s_mov_b32 s48, s4
    s_mov_b32 s49, s5
    s_mov_b32 s50, 2560
    s_mov_b32 s51, 0x00020000
    s_barrier
    s_cmp_eq_u32 s3, 4
    s_cbranch_scc0 L_not4
    s_waitcnt lgkmcnt(0)
    s_add_u32 s30, s30, 1
    s_and_b32 s68, s30, 0xff
    s_and_b32 s67, s30, 0x00010001
    v_mov_b32 v3, s68
    s_mov_b32 s58, 65536
L_phA:
    s_lshl_b32 s52, s36, 10
    s_add_u32 s58, s58, s52
    v_bfe_u32 v6, v1, 2, 1
    v_lshlrev_b32 v6, 8, v6
    v_lshrrev_b32 v7, 4, v1
    v_mad_u32_u24 v6, v7, 40, v6
    s_waitcnt vmcnt(12)
    v_perm_b32 v116, v40, v36, s62
    v_perm_b32 v117, v48, v44, s62
    v_perm_b32 v118, v56, v52, s62
    v_perm_b32 v119, v64, v60, s62
    v_perm_b32 v120, v40, v36, s63
    v_perm_b32 v121, v48, v44, s63
    v_perm_b32 v122, v56, v52, s63
    v_perm_b32 v123, v64, v60, s63
    v_perm_b32 v124, v41, v37, s62
    v_perm_b32 v125, v49, v45, s62
    v_perm_b32 v126, v57, v53, s62
    v_perm_b32 v127, v65, v61, s62
    v_perm_b32 v128, v41, v37, s63
    v_perm_b32 v129, v49, v45, s63
    v_perm_b32 v130, v57, v53, s63
    v_perm_b32 v131, v65, v61, s63
    v_perm_b32 v132, v42, v38, s62
    v_perm_b32 v133, v50, v46, s62
    v_perm_b32 v134, v58, v54, s62
    v_perm_b32 v135, v66, v62, s62
    v_perm_b32 v136, v42, v38, s63
    v_perm_b32 v137, v50, v46, s63
    v_perm_b32 v138, v58, v54, s63
    v_perm_b32 v139, v66, v62, s63
    v_perm_b32 v140, v43, v39, s62
    v_perm_b32 v141, v51, v47, s62
    v_perm_b32 v142, v59, v55, s62
    v_perm_b32 v143, v67, v63, s62
    v_perm_b32 v144, v43, v39, s63
    v_perm_b32 v145, v51, v47, s63
    v_perm_b32 v146, v59, v55, s63
    v_perm_b32 v147, v67, v63, s63
    v_mov_b32 v4, 0
Lw_recurrent_sc_1:
    ds_read_b32 v5, v4 offset:4368
    s_waitcnt lgkmcnt(0)
    v_readfirstlane_b32 s52, v5
    s_cmp_ge_u32 s52, 1
    s_cbranch_scc0 Lw_recurrent_sc_1
    ds_read_b64 v[24:25], v6 offset:5632
    ds_read_b64 v[26:27], v6 offset:5640
    ds_read_b64 v[28:29], v6 offset:5648
    ds_read_b64 v[30:31], v6 offset:5656
    ds_read_b64 v[32:33], v6 offset:5664
    s_waitcnt vmcnt(4)
    s_waitcnt lgkmcnt(0)
    v_mfma_f32_16x16x32_bf16 v[196:199], v[24:27], v[116:119], 0
    v_perm_b32 v148, v72, v68, s62
    v_perm_b32 v149, v80, v76, s62
    v_perm_b32 v150, v88, v84, s62
    v_perm_b32 v151, v96, v92, s62
    v_mfma_f32_16x16x32_bf16 v[200:203], v[24:27], v[120:123], 0
    v_perm_b32 v152, v72, v68, s63
    v_perm_b32 v153, v80, v76, s63
    v_perm_b32 v154, v88, v84, s63
    v_perm_b32 v155, v96, v92, s63
    v_mfma_f32_16x16x32_bf16 v[204:207], v[24:27], v[124:127], 0
    v_perm_b32 v156, v73, v69, s62
    v_perm_b32 v157, v81, v77, s62
    v_perm_b32 v158, v89, v85, s62
    v_perm_b32 v159, v97, v93, s62
    v_mfma_f32_16x16x32_bf16 v[208:211], v[24:27], v[128:131], 0
    v_perm_b32 v160, v73, v69, s63
    v_perm_b32 v161, v81, v77, s63
    v_perm_b32 v162, v89, v85, s63
    v_perm_b32 v163, v97, v93, s63
    v_mfma_f32_16x16x32_bf16 v[212:215], v[24:27], v[132:135], 0
    v_perm_b32 v164, v74, v70, s62
    v_perm_b32 v165, v82, v78, s62
    v_perm_b32 v166, v90, v86, s62
    v_perm_b32 v167, v98, v94, s62
    v_mfma_f32_16x16x32_bf16 v[216:219], v[24:27], v[136:139], 0
    v_perm_b32 v168, v74, v70, s63
    v_perm_b32 v169, v82, v78, s63
    v_perm_b32 v170, v90, v86, s63
    v_perm_b32 v171, v98, v94, s63
    v_mfma_f32_16x16x32_bf16 v[220:223], v[24:27], v[140:143], 0
    v_perm_b32 v172, v75, v71, s62
    v_perm_b32 v173, v83, v79, s62
    v_perm_b32 v174, v91, v87, s62
    v_perm_b32 v175, v99, v95, s62
    v_mfma_f32_16x16x32_bf16 v[224:227], v[24:27], v[144:147], 0
    v_perm_b32 v176, v75, v71, s63
    v_perm_b32 v177, v83, v79, s63
    v_perm_b32 v178, v91, v87, s63
    v_perm_b32 v179, v99, v95, s63
    s_waitcnt vmcnt(0)
    v_mfma_f32_16x16x32_bf16 v[196:199], v[28:31], v[148:151], v[196:199]
    v_perm_b32 v180, v104, v100, s62
    v_perm_b32 v181, v112, v108, s62
    v_mfma_f32_16x16x32_bf16 v[200:203], v[28:31], v[152:155], v[200:203]
    v_perm_b32 v182, v104, v100, s63
    v_perm_b32 v183, v112, v108, s63
    v_mfma_f32_16x16x32_bf16 v[204:207], v[28:31], v[156:159], v[204:207]
    v_perm_b32 v184, v105, v101, s62
    v_perm_b32 v185, v113, v109, s62
    v_mfma_f32_16x16x32_bf16 v[208:211], v[28:31], v[160:163], v[208:211]
    v_perm_b32 v186, v105, v101, s63
    v_perm_b32 v187, v113, v109, s63
    v_mfma_f32_16x16x32_bf16 v[212:215], v[28:31], v[164:167], v[212:215]
    v_perm_b32 v188, v106, v102, s62
    v_perm_b32 v189, v114, v110, s62
    v_mfma_f32_16x16x32_bf16 v[216:219], v[28:31], v[168:171], v[216:219]
    v_perm_b32 v190, v106, v102, s63
    v_perm_b32 v191, v114, v110, s63
    v_mfma_f32_16x16x32_bf16 v[220:223], v[28:31], v[172:175], v[220:223]
    v_perm_b32 v192, v107, v103, s62
    v_perm_b32 v193, v115, v111, s62
    v_mfma_f32_16x16x32_bf16 v[224:227], v[28:31], v[176:179], v[224:227]
    v_perm_b32 v194, v107, v103, s63
    v_perm_b32 v195, v115, v111, s63
    v_mfma_f32_16x16x16_bf16 v[196:199], v[32:33], v[180:181], v[196:199]
    v_mfma_f32_16x16x16_bf16 v[200:203], v[32:33], v[182:183], v[200:203]
    v_mfma_f32_16x16x16_bf16 v[204:207], v[32:33], v[184:185], v[204:207]
    v_mfma_f32_16x16x16_bf16 v[208:211], v[32:33], v[186:187], v[208:211]
    v_mfma_f32_16x16x16_bf16 v[212:215], v[32:33], v[188:189], v[212:215]
    v_mfma_f32_16x16x16_bf16 v[216:219], v[32:33], v[190:191], v[216:219]
    v_mfma_f32_16x16x16_bf16 v[220:223], v[32:33], v[192:193], v[220:223]
    v_mfma_f32_16x16x16_bf16 v[224:227], v[32:33], v[194:195], v[224:227]
    s_nop 4
    v_cndmask_b32 v12, v196, v212, s[60:61]
    v_cndmask_b32 v13, v200, v216, s[60:61]
    v_cndmask_b32 v14, v204, v220, s[60:61]
    v_cndmask_b32 v15, v208, v224, s[60:61]
    v_and_or_b32 v12, v12, s64, v3
    v_and_or_b32 v13, v13, s64, v3
    v_and_or_b32 v14, v14, s64, v3
    v_and_or_b32 v15, v15, s64, v3
    s_cmp_eq_u32 s3, 4
    s_cbranch_scc0 Lb_recurrent_sc_2
    buffer_store_dwordx4 v[12:15], v2, s[40:43], s58 offen
    s_mov_b64 exec, 1
    v_mov_b32 v4, 0
    v_mov_b32 v5, 1
    ds_add_u32 v4, v5 offset:4352
    s_mov_b64 exec, -1
    s_add_u32 s58, s58, 786432
    v_mov_b32 v4, 0
Lw_recurrent_sc_3:
    s_sleep 1
    ds_read_b32 v5, v4 offset:4372
    s_waitcnt lgkmcnt(0)
    v_readfirstlane_b32 s52, v5
    s_cmp_ge_u32 s52, 1
    s_cbranch_scc0 Lw_recurrent_sc_3
Lb_recurrent_sc_2:
    buffer_store_dwordx4 v[12:15], v2, s[40:43], s58 offen sc1
    s_branch L_gq
L_not4:
    s_cmp_lt_u32 s3, 4
    s_cbranch_scc1 L_tw
    s_cmp_eq_u32 s3, 5
    s_cbranch_scc1 L_w5
    s_cmp_eq_u32 s3, 6
    s_cbranch_scc1 L_w6
    v_bfe_u32 v7, v1, 2, 1
    v_lshlrev_b32 v7, 8, v7
    v_lshl_add_u32 v10, v10, 2, v7
    v_add_u32 v10, 5632, v10
    s_waitcnt vmcnt(2)
    v_lshlrev_b32 v180, 16, v12
    v_and_b32 v181, s65, v12
    v_lshlrev_b32 v182, 16, v13
    v_and_b32 v183, s65, v13
    v_lshlrev_b32 v184, 16, v14
    v_and_b32 v185, s65, v14
    v_lshlrev_b32 v186, 16, v15
    v_and_b32 v187, s65, v15
    v_lshlrev_b32 v188, 16, v16
    v_and_b32 v189, s65, v16
    v_lshlrev_b32 v190, 16, v17
    v_and_b32 v191, s65, v17
    v_lshlrev_b32 v192, 16, v18
    v_and_b32 v193, s65, v18
    v_lshlrev_b32 v194, 16, v19
    v_and_b32 v195, s65, v19
    v_lshlrev_b32 v196, 16, v20
    v_and_b32 v197, s65, v20
    v_lshlrev_b32 v198, 16, v21
    v_and_b32 v199, s65, v21
    v_pk_add_f32 v[116:117], v[180:181], v[190:191]
    v_pk_add_f32 v[118:119], v[182:183], v[192:193]
    v_pk_add_f32 v[120:121], v[184:185], v[194:195]
    v_pk_add_f32 v[122:123], v[186:187], v[196:197]
    v_pk_add_f32 v[124:125], v[188:189], v[198:199]
    v_pk_add_f32 v[116:117], v[116:117], v[118:119]
    v_pk_add_f32 v[120:121], v[120:121], v[122:123]
    v_pk_add_f32 v[116:117], v[116:117], v[124:125]
    v_pk_add_f32 v[116:117], v[116:117], v[120:121]
    v_add_f32 v4, v116, v117
    s_nop 1
    v_add_f32_dpp v4, v4, v4 quad_perm:[1,0,3,2] row_mask:0xf bank_mask:0xf
    s_nop 1
    v_add_f32_dpp v4, v4, v4 quad_perm:[2,3,0,1] row_mask:0xf bank_mask:0xf
    s_nop 1
    v_add_f32_dpp v4, v4, v4 row_ror:8 row_mask:0xf bank_mask:0xf
    v_mov_b32 v5, v4
    s_nop 1
    v_permlane16_swap_b32 v5, v4
    v_add_f32 v4, v4, v5
    v_mov_b32 v5, v4
    s_nop 1
    v_permlane32_swap_b32 v5, v4
    v_add_f32 v4, v4, v5
    v_mul_f32 v4, 0xbacccccd, v4
    v_pk_add_f32 v[180:181], v[180:181], v[4:5] op_sel_hi:[1,0]
    v_pk_add_f32 v[182:183], v[182:183], v[4:5] op_sel_hi:[1,0]
    v_pk_add_f32 v[184:185], v[184:185], v[4:5] op_sel_hi:[1,0]
    v_pk_add_f32 v[186:187], v[186:187], v[4:5] op_sel_hi:[1,0]
    v_pk_add_f32 v[188:189], v[188:189], v[4:5] op_sel_hi:[1,0]
    v_pk_add_f32 v[190:191], v[190:191], v[4:5] op_sel_hi:[1,0]
    v_pk_add_f32 v[192:193], v[192:193], v[4:5] op_sel_hi:[1,0]
    v_pk_add_f32 v[194:195], v[194:195], v[4:5] op_sel_hi:[1,0]
    v_pk_add_f32 v[196:197], v[196:197], v[4:5] op_sel_hi:[1,0]
    v_pk_add_f32 v[198:199], v[198:199], v[4:5] op_sel_hi:[1,0]
    v_pk_mul_f32 v[6:7], v[180:181], v[180:181]
    v_pk_mul_f32 v[116:117], v[182:183], v[182:183]
    v_pk_fma_f32 v[6:7], v[184:185], v[184:185], v[6:7]
    v_pk_fma_f32 v[116:117], v[186:187], v[186:187], v[116:117]
    v_pk_fma_f32 v[6:7], v[188:189], v[188:189], v[6:7]
    v_pk_fma_f32 v[116:117], v[190:191], v[190:191], v[116:117]
    v_pk_fma_f32 v[6:7], v[192:193], v[192:193], v[6:7]
    v_pk_fma_f32 v[116:117], v[194:195], v[194:195], v[116:117]
    v_pk_fma_f32 v[6:7], v[196:197], v[196:197], v[6:7]
    v_pk_fma_f32 v[116:117], v[198:199], v[198:199], v[116:117]
    v_pk_add_f32 v[6:7], v[6:7], v[116:117]
    v_cvt_pk_bf16_f32 v4, v4, v4
    v_and_b32 v4, s65, v4
    v_add_f32 v6, v6, v7
    s_waitcnt vmcnt(0)
    v_lshlrev_b32 v180, 16, v22
    v_and_b32 v181, s65, v22
    v_lshlrev_b32 v182, 16, v23
    v_and_b32 v183, s65, v23
    v_add_f32_dpp v6, v6, v6 quad_perm:[1,0,3,2] row_mask:0xf bank_mask:0xf
    v_pk_add_f32 v[180:181], v[180:181], v[4:5] op_sel_hi:[1,0]
    v_pk_add_f32 v[182:183], v[182:183], v[4:5] op_sel_hi:[1,0]
    v_add_f32_dpp v6, v6, v6 quad_perm:[2,3,0,1] row_mask:0xf bank_mask:0xf
    v_cvt_pk_bf16_f32 v22, v180, v181
    v_cvt_pk_bf16_f32 v23, v182, v183
    v_add_f32_dpp v6, v6, v6 row_ror:8 row_mask:0xf bank_mask:0xf
    v_lshlrev_b32 v180, 16, v22
    v_and_b32 v181, s65, v22
    v_lshlrev_b32 v182, 16, v23
    v_and_b32 v183, s65, v23
    v_mov_b32 v5, v6
    s_nop 1
    v_permlane16_swap_b32 v5, v6
    v_add_f32 v6, v6, v5
    v_mov_b32 v5, v6
    s_nop 1
    v_permlane32_swap_b32 v5, v6
    v_add_f32 v6, v6, v5
    v_mul_f32 v6, 0x3acccccd, v6
    v_cvt_pk_bf16_f32 v6, v6, v6
    v_and_b32 v6, s65, v6
    v_add_f32 v6, 0x3727c5ac, v6
    v_cvt_pk_bf16_f32 v6, v6, v6
    v_and_b32 v6, s65, v6
    v_sqrt_f32 v6, v6
    s_nop 0
    v_cvt_pk_bf16_f32 v6, v6, v6
    v_and_b32 v6, s65, v6
    v_rcp_f32 v6, v6
    s_nop 0
    v_pk_mul_f32 v[180:181], v[180:181], v[6:7] op_sel_hi:[1,0]
    v_pk_mul_f32 v[182:183], v[182:183], v[6:7] op_sel_hi:[1,0]
    v_cvt_pk_bf16_f32 v22, v180, v181
    v_cvt_pk_bf16_f32 v23, v182, v183
    ds_write2_b32 v10, v22, v23 offset0:0 offset1:32
    s_mov_b64 exec, 1
    v_mov_b32 v4, 0
    v_mov_b32 v5, 1
    ds_add_u32 v4, v5 offset:4368
    s_mov_b64 exec, -1
    s_waitcnt lgkmcnt(0)
    s_add_u32 s30, s30, 1
    s_and_b32 s68, s30, 0xff
    s_and_b32 s67, s30, 0x00010001
    v_mov_b32 v3, s68
    v_lshrrev_b32 v4, 4, v1
    v_mul_u32_u24 v4, 69120, v4
    v_and_b32 v5, 7, v1
    v_lshl_add_u32 v4, v5, 4, v4
    s_mul_i32 s52, s32, 276480
    s_lshl_b32 s53, s31, 7
    s_add_u32 s52, s52, s53
    v_add_u32 v4, s52, v4
    v_mov_b32 v5, 0
    s_mov_b32 s54, 0xff00ff00
    s_mov_b32 s55, 0xff00ff00
    v_mov_b32 v6, s18
    v_mov_b32 v7, s20
    v_cndmask_b32 v250, v6, v7, s[54:55]
    v_mov_b32 v6, s19
    v_mov_b32 v7, s21
    v_cndmask_b32 v251, v6, v7, s[54:55]
    v_lshl_add_u64 v[250:251], v[4:5], 0, v[250:251]
    s_cmp_ge_u32 s31, 27
    s_cbranch_scc1 L_gq
    v_mov_b32 v4, 0
Lw_recurrent_sc_4:
    ds_read_b32 v5, v4 offset:4352
    s_waitcnt lgkmcnt(0)
    v_readfirstlane_b32 s52, v5
    s_cmp_ge_u32 s52, 1
    s_cbranch_scc0 Lw_recurrent_sc_4
    s_mov_b32 s56, 3456
    s_mov_b32 s57, 0
    global_load_dwordx4 v[36:39], v[250:251], off nt
    v_lshl_add_u64 v[250:251], v[250:251], 0, s[56:57]
    global_load_dwordx4 v[40:43], v[250:251], off nt
    v_lshl_add_u64 v[250:251], v[250:251], 0, s[56:57]
    global_load_dwordx4 v[44:47], v[250:251], off nt
    v_lshl_add_u64 v[250:251], v[250:251], 0, s[56:57]
    global_load_dwordx4 v[48:51], v[250:251], off nt
    v_lshl_add_u64 v[250:251], v[250:251], 0, s[56:57]
    global_load_dwordx4 v[52:55], v[250:251], off nt
    v_lshl_add_u64 v[250:251], v[250:251], 0, s[56:57]
    global_load_dwordx4 v[56:59], v[250:251], off nt
    v_lshl_add_u64 v[250:251], v[250:251], 0, s[56:57]
    global_load_dwordx4 v[60:63], v[250:251], off nt
    v_lshl_add_u64 v[250:251], v[250:251], 0, s[56:57]
    global_load_dwordx4 v[64:67], v[250:251], off nt
    v_lshl_add_u64 v[250:251], v[250:251], 0, s[56:57]
    global_load_dwordx4 v[68:71], v[250:251], off nt
    v_lshl_add_u64 v[250:251], v[250:251], 0, s[56:57]
    global_load_dwordx4 v[72:75], v[250:251], off nt
    v_lshl_add_u64 v[250:251], v[250:251], 0, s[56:57]
    global_load_dwordx4 v[76:79], v[250:251], off nt
    v_lshl_add_u64 v[250:251], v[250:251], 0, s[56:57]
    global_load_dwordx4 v[80:83], v[250:251], off nt
    v_lshl_add_u64 v[250:251], v[250:251], 0, s[56:57]
    global_load_dwordx4 v[84:87], v[250:251], off nt
    v_lshl_add_u64 v[250:251], v[250:251], 0, s[56:57]
    global_load_dwordx4 v[88:91], v[250:251], off nt
    v_lshl_add_u64 v[250:251], v[250:251], 0, s[56:57]
    global_load_dwordx4 v[92:95], v[250:251], off nt
    v_lshl_add_u64 v[250:251], v[250:251], 0, s[56:57]
    global_load_dwordx4 v[96:99], v[250:251], off nt
    v_lshl_add_u64 v[250:251], v[250:251], 0, s[56:57]
    global_load_dwordx4 v[100:103], v[250:251], off nt
    v_lshl_add_u64 v[250:251], v[250:251], 0, s[56:57]
    global_load_dwordx4 v[104:107], v[250:251], off nt
    v_lshl_add_u64 v[250:251], v[250:251], 0, s[56:57]
    global_load_dwordx4 v[108:111], v[250:251], off nt
    v_lshl_add_u64 v[250:251], v[250:251], 0, s[56:57]
    global_load_dwordx4 v[112:115], v[250:251], off nt
    s_mov_b32 s58, 327680
    s_branch L_phA
L_w6:
    s_waitcnt lgkmcnt(0)
    s_add_u32 s30, s30, 1
    s_and_b32 s68, s30, 0xff
    s_and_b32 s67, s30, 0x00010001
    v_mov_b32 v3, s68
    s_branch L_gq
L_w5:
    s_setprio 1
    s_mov_b32 s44, s10
    s_mov_b32 s45, s11
    s_mov_b32 s46, 4194304
    s_mov_b32 s47, 0x00020000
    v_and_b32 v4, 15, v1
    v_lshlrev_b32 v4, 15, v4
    v_and_b32 v5, 48, v1
    v_add_u32 v4, v4, v5
    s_lshl_b32 s52, s36, 10
    s_add_u32 s52, s52, 65536
    buffer_load_dwordx4 v[80:83], v2, s[40:43], s52 offen sc1
    s_lshl_b32 s52, s32, 19
    s_lshl_b32 s53, s31, 8
    s_add_u32 s52, s52, s53
    buffer_load_dwordx4 v[16:19], v4, s[44:47], s52 offen offset:0 nt
    buffer_load_dwordx4 v[20:23], v4, s[44:47], s52 offen offset:64 nt
    buffer_load_dwordx4 v[24:27], v4, s[44:47], s52 offen offset:128 nt
    buffer_load_dwordx4 v[28:31], v4, s[44:47], s52 offen offset:192 nt
    s_add_u32 s52, s52, 8192
    buffer_load_dwordx4 v[32:35], v4, s[44:47], s52 offen offset:0 nt
    buffer_load_dwordx4 v[36:39], v4, s[44:47], s52 offen offset:64 nt
    buffer_load_dwordx4 v[40:43], v4, s[44:47], s52 offen offset:128 nt
    buffer_load_dwordx4 v[44:47], v4, s[44:47], s52 offen offset:192 nt
    s_add_u32 s52, s52, 8192
    buffer_load_dwordx4 v[48:51], v4, s[44:47], s52 offen offset:0 nt
    buffer_load_dwordx4 v[52:55], v4, s[44:47], s52 offen offset:64 nt
    buffer_load_dwordx4 v[56:59], v4, s[44:47], s52 offen offset:128 nt
    buffer_load_dwordx4 v[60:63], v4, s[44:47], s52 offen offset:192 nt
    s_add_u32 s52, s52, 8192
    buffer_load_dwordx4 v[64:67], v4, s[44:47], s52 offen offset:0 nt
    buffer_load_dwordx4 v[68:71], v4, s[44:47], s52 offen offset:64 nt
    buffer_load_dwordx4 v[72:75], v4, s[44:47], s52 offen offset:128 nt
    buffer_load_dwordx4 v[76:79], v4, s[44:47], s52 offen offset:192 nt
    s_waitcnt lgkmcnt(0)
    s_add_u32 s30, s30, 1
    s_and_b32 s68, s30, 0xff
    s_and_b32 s67, s30, 0x00010001
    v_mov_b32 v3, s68
    v_and_b32 v6, 31, v1
    v_lshlrev_b32 v6, 4, v6
    v_lshrrev_b32 v5, 5, v1
    v_lshl_add_u32 v6, v5, 3, v6
    v_bfe_u32 v7, v1, 2, 1
    v_lshlrev_b32 v7, 8, v7
    v_and_b32 v5, 48, v1
    v_add_u32 v7, v7, v5
    v_and_b32 v12, 15, v1
    v_lshlrev_b32 v12, 4, v12
    v_bfe_u32 v5, v1, 4, 1
    v_lshl_add_u32 v12, v5, 16, v12
    s_lshl_b32 s57, s36, 8
    s_add_u32 s57, s57, 1638400
    s_and_b32 s53, s30, 0xffff
    v_mov_b32 v13, s53
    s_lshl_b32 s56, s31, 13
    s_add_u32 s56, s56, 65536
    s_waitcnt vmcnt(4)
    v_mov_b32 v4, 0
Lw_recurrent_sc_5:
    ds_read_b32 v5, v4 offset:4352
    s_waitcnt lgkmcnt(0)
    v_readfirstlane_b32 s52, v5
    s_cmp_ge_u32 s52, 1
    s_cbranch_scc0 Lw_recurrent_sc_5
    s_mov_b32 s66, 262144
    s_cmp_eq_u32 s66, 262138
    s_cbranch_scc0 Lb_recurrent_sc_8
    s_mov_b64 s[72:73], exec
    s_mov_b64 exec, 1
    v_mov_b32 v4, 0
    v_mov_b32 v14, 1
    ds_add_u32 v4, v14 offset:4372
    s_mov_b64 exec, -1
    s_mov_b64 exec, s[72:73]
Lb_recurrent_sc_8:
    s_cmp_gt_u32 s66, 262138
    s_cselect_b32 s52, 0, 786432
    s_add_u32 s52, s52, s56
    s_add_u32 s53, s52, 4096
    buffer_load_dwordx4 v[80:83], v2, s[40:43], s52 offen offset:0 sc1
    buffer_load_dwordx4 v[84:87], v2, s[40:43], s52 offen offset:1024 sc1
    buffer_load_dwordx4 v[88:91], v2, s[40:43], s52 offen offset:2048 sc1
    buffer_load_dwordx4 v[92:95], v2, s[40:43], s52 offen offset:3072 sc1
    buffer_load_dwordx4 v[96:99], v2, s[40:43], s53 offen offset:0 sc1
    buffer_load_dwordx4 v[100:103], v2, s[40:43], s53 offen offset:1024 sc1
    buffer_load_dwordx4 v[104:107], v2, s[40:43], s53 offen offset:2048 sc1
    buffer_load_dwordx4 v[108:111], v2, s[40:43], s53 offen offset:3072 sc1
    s_mov_b64 exec, 1
    v_mov_b32 v4, 0
    v_mov_b32 v5, 1
    ds_add_u32 v4, v5 offset:4364
    s_mov_b64 exec, -1
Lp_recurrent_sc_6:
    s_waitcnt vmcnt(7)
    v_xor_b32 v80, s68, v80
    v_xor_b32 v81, s68, v81
    v_xor_b32 v82, s68, v82
    v_xor_b32 v83, s68, v83
    v_or3_b32 v4, v80, v81, v82
    v_or_b32 v4, v4, v83
    s_waitcnt vmcnt(6)
    v_xor_b32 v84, s68, v84
    v_xor_b32 v85, s68, v85
    v_xor_b32 v86, s68, v86
    v_xor_b32 v87, s68, v87
    v_or3_b32 v4, v4, v84, v85
    v_or3_b32 v4, v4, v86, v87
    s_waitcnt vmcnt(5)
    v_xor_b32 v88, s68, v88
    v_xor_b32 v89, s68, v89
    v_xor_b32 v90, s68, v90
    v_xor_b32 v91, s68, v91
    v_or3_b32 v4, v4, v88, v89
    v_or3_b32 v4, v4, v90, v91
    s_waitcnt vmcnt(4)
    v_xor_b32 v92, s68, v92
    v_xor_b32 v93, s68, v93
    v_xor_b32 v94, s68, v94
    v_xor_b32 v95, s68, v95
    v_or3_b32 v4, v4, v92, v93
    v_or3_b32 v4, v4, v94, v95
    s_waitcnt vmcnt(3)
    v_xor_b32 v96, s68, v96
    v_xor_b32 v97, s68, v97
    v_xor_b32 v98, s68, v98
    v_xor_b32 v99, s68, v99
    v_or3_b32 v4, v4, v96, v97
    v_or3_b32 v4, v4, v98, v99
    s_waitcnt vmcnt(2)
    v_xor_b32 v100, s68, v100
    v_xor_b32 v101, s68, v101
    v_xor_b32 v102, s68, v102
    v_xor_b32 v103, s68, v103
    v_or3_b32 v4, v4, v100, v101
    v_or3_b32 v4, v4, v102, v103
    s_waitcnt vmcnt(1)
    v_xor_b32 v104, s68, v104
    v_xor_b32 v105, s68, v105
    v_xor_b32 v106, s68, v106
    v_xor_b32 v107, s68, v107
    v_or3_b32 v4, v4, v104, v105
    v_or3_b32 v4, v4, v106, v107
    s_waitcnt vmcnt(0)
    v_xor_b32 v108, s68, v108
    v_xor_b32 v109, s68, v109
    v_xor_b32 v110, s68, v110
    v_xor_b32 v111, s68, v111
    v_or3_b32 v4, v4, v108, v109
    v_or3_b32 v4, v4, v110, v111
    v_and_b32 v4, 255, v4
    v_cmp_ne_u32 vcc, 0, v4
    s_and_b64 exec, exec, vcc
    s_cbranch_scc0 Ld_recurrent_sc_7
    s_sub_u32 s66, s66, 1
    s_cbranch_scc1 Ld_recurrent_sc_7
    s_cmp_eq_u32 s66, 262138
    s_cbranch_scc0 Lb_recurrent_sc_9
    s_mov_b64 s[72:73], exec
    s_mov_b64 exec, 1
    v_mov_b32 v4, 0
    v_mov_b32 v14, 1
    ds_add_u32 v4, v14 offset:4372
    s_mov_b64 exec, -1
    s_mov_b64 exec, s[72:73]
Lb_recurrent_sc_9:
    s_cmp_gt_u32 s66, 262138
    s_cselect_b32 s52, 0, 786432
    s_add_u32 s52, s52, s56
    s_add_u32 s53, s52, 4096
    buffer_load_dwordx4 v[80:83], v2, s[40:43], s52 offen offset:0 sc1
    buffer_load_dwordx4 v[84:87], v2, s[40:43], s52 offen offset:1024 sc1
    buffer_load_dwordx4 v[88:91], v2, s[40:43], s52 offen offset:2048 sc1
    buffer_load_dwordx4 v[92:95], v2, s[40:43], s52 offen offset:3072 sc1
    buffer_load_dwordx4 v[96:99], v2, s[40:43], s53 offen offset:0 sc1
    buffer_load_dwordx4 v[100:103], v2, s[40:43], s53 offen offset:1024 sc1
    buffer_load_dwordx4 v[104:107], v2, s[40:43], s53 offen offset:2048 sc1
    buffer_load_dwordx4 v[108:111], v2, s[40:43], s53 offen offset:3072 sc1
    s_branch Lp_recurrent_sc_6
Ld_recurrent_sc_7:
    s_mov_b64 exec, -1
    v_pk_add_f32 v[80:81], v[80:81], v[96:97]
    v_pk_add_f32 v[82:83], v[82:83], v[98:99]
    v_pk_add_f32 v[84:85], v[84:85], v[100:101]
    v_pk_add_f32 v[86:87], v[86:87], v[102:103]
    v_pk_add_f32 v[88:89], v[88:89], v[104:105]
    v_pk_add_f32 v[90:91], v[90:91], v[106:107]
    v_pk_add_f32 v[92:93], v[92:93], v[108:109]
    v_pk_add_f32 v[94:95], v[94:95], v[110:111]
    v_pk_add_f32 v[80:81], v[80:81], v[88:89]
    v_pk_add_f32 v[82:83], v[82:83], v[90:91]
    v_pk_add_f32 v[84:85], v[84:85], v[92:93]
    v_pk_add_f32 v[86:87], v[86:87], v[94:95]
    v_pk_add_f32 v[80:81], v[80:81], v[84:85]
    v_pk_add_f32 v[82:83], v[82:83], v[86:87]
    s_mov_b64 exec, 1
    v_mov_b32 v4, 0
    v_mov_b32 v5, 1
    ds_add_u32 v4, v5 offset:4372
    s_mov_b64 exec, -1
    v_cvt_pk_bf16_f32 v80, v80, v81
    v_cvt_pk_bf16_f32 v81, v82, v83
    ds_write_b64 v6, v[80:81] offset:4608
    ds_read_b128 v[128:131], v7 offset:4608
    ds_read_b128 v[132:135], v7 offset:4672
    ds_read_b128 v[136:139], v7 offset:4736
    ds_read_b128 v[140:143], v7 offset:4800
    s_waitcnt lgkmcnt(3)
    v_mfma_f32_16x16x32_bf16 v[112:115], v[128:131], v[16:19], 0
    v_mfma_f32_16x16x32_bf16 v[116:119], v[128:131], v[32:35], 0
    v_mfma_f32_16x16x32_bf16 v[120:123], v[128:131], v[48:51], 0
    v_mfma_f32_16x16x32_bf16 v[124:127], v[128:131], v[64:67], 0
    s_waitcnt lgkmcnt(2)
    v_mfma_f32_16x16x32_bf16 v[112:115], v[132:135], v[20:23], v[112:115]
    v_mfma_f32_16x16x32_bf16 v[116:119], v[132:135], v[36:39], v[116:119]
    v_mfma_f32_16x16x32_bf16 v[120:123], v[132:135], v[52:55], v[120:123]
    v_mfma_f32_16x16x32_bf16 v[124:127], v[132:135], v[68:71], v[124:127]
    s_waitcnt lgkmcnt(1)
    v_mfma_f32_16x16x32_bf16 v[112:115], v[136:139], v[24:27], v[112:115]
    v_mfma_f32_16x16x32_bf16 v[116:119], v[136:139], v[40:43], v[116:119]
    v_mfma_f32_16x16x32_bf16 v[120:123], v[136:139], v[56:59], v[120:123]
    v_mfma_f32_16x16x32_bf16 v[124:127], v[136:139], v[72:75], v[124:127]
    s_waitcnt lgkmcnt(0)
    v_mfma_f32_16x16x32_bf16 v[112:115], v[140:143], v[28:31], v[112:115]
    v_mfma_f32_16x16x32_bf16 v[116:119], v[140:143], v[44:47], v[116:119]
    v_mfma_f32_16x16x32_bf16 v[120:123], v[140:143], v[60:63], v[120:123]
    v_mfma_f32_16x16x32_bf16 v[124:127], v[140:143], v[76:79], v[124:127]
    s_nop 5
    v_cvt_pk_bf16_f32 v9, v112, v116
    s_nop 0
    v_cvt_pk_bf16_f32 v11, v120, v124
    v_lshl_or_b32 v8, v9, 16, v13
    v_and_or_b32 v9, v9, s65, v13
    v_lshl_or_b32 v10, v11, 16, v13
    v_and_or_b32 v11, v11, s65, v13
    s_mov_b32 exec_hi, 0
    buffer_store_dwordx4 v[8:11], v12, s[40:43], s57 offen sc1
    s_mov_b64 exec, 1
    v_mov_b32 v4, 0
    v_mov_b32 v5, 1
    ds_add_u32 v4, v5 offset:4356
    s_mov_b64 exec, -1
L_gq:
    s_setprio 1
    s_cmp_eq_u32 s3, 4
    s_cbranch_scc0 L_t56
    s_mov_b32 s44, s12
    s_mov_b32 s45, s13
    s_mov_b32 s46, 4194304
    s_mov_b32 s47, 0x00020000
    v_lshrrev_b32 v4, 4, v1
    v_lshlrev_b32 v4, 15, v4
    v_and_b32 v5, 15, v1
    v_lshl_add_u32 v11, v5, 4, v4
    s_lshl_b32 s52, s32, 19
    s_lshl_b32 s53, s31, 8
    s_add_u32 s58, s52, s53
    s_branch L_gq2
L_t56:
    s_sub_u32 s54, s3, 5
    s_lshl_b32 s52, s31, 1
    s_add_u32 s52, s52, s54
    s_mov_b32 s55, s32
    s_mov_b32 s44, s14
    s_mov_b32 s45, s15
    s_mov_b32 s46, 5242880
    s_mov_b32 s47, 0x00020000
    s_cmp_lt_u32 s32, 5
    s_cbranch_scc1 L_tld
    s_mov_b32 s52, s31
    s_sub_u32 s55, s32, 5
    s_lshl_b32 s55, s55, 1
    s_add_u32 s55, s55, s54
    s_mov_b32 s44, s22
    s_mov_b32 s45, s23
    s_mov_b32 s46, 2211840
    s_mov_b32 s47, 0x00020000
    s_cmp_lt_u32 s55, 5
    s_cselect_b32 s52, s52, 64
L_tld:
    s_mov_b32 s37, s52
    s_mov_b32 s38, s55
    s_mul_i32 s52, s52, 81920
    s_lshl_b32 s53, s55, 8
    s_add_u32 s58, s52, s53
    v_lshrrev_b32 v4, 4, v1
    v_mul_u32_u24 v4, 20480, v4
    v_and_b32 v5, 15, v1
    v_lshl_add_u32 v11, v5, 4, v4
L_gq2:
    v_lshrrev_b32 v4, 2, v1
    v_mul_u32_u24 v9, 1056, v4
    v_and_b32 v4, 3, v1
    v_lshl_add_u32 v9, v4, 3, v9
    s_lshl_b32 s54, s3, 7
    s_add_u32 s54, s54, 23040
    v_add_u32 v9, s54, v9
    v_add_u32 v10, 67584, v9
    v_and_b32 v4, 15, v1
    v_lshlrev_b32 v4, 3, v4
    v_lshrrev_b32 v13, 4, v1
    v_lshl_add_u32 v13, v13, 19, v4
    s_lshl_b32 s52, s34, 21
    s_lshl_b32 s54, s3, 14
    s_add_u32 s52, s52, s54
    s_lshl_b32 s54, s33, 7
    s_add_u32 s52, s52, s54
    s_add_u32 s39, s52, 3145728
    v_mov_b32 v4, 0
Lw_recurrent_sc_10:
    s_sleep 1
    ds_read_b32 v5, v4 offset:4356
    s_waitcnt lgkmcnt(0)
    v_readfirstlane_b32 s52, v5
    s_cmp_ge_u32 s52, 2
    s_cbranch_scc0 Lw_recurrent_sc_10
    s_lshl_b32 s52, s35, 16
    s_lshl_b32 s53, s34, 15
    s_add_u32 s52, s52, s53
    s_sub_u32 s54, s3, 4
    s_lshl_b32 s53, s54, 13
    s_add_u32 s52, s52, s53
    s_add_u32 s52, s52, 1638400
    s_add_u32 s53, s52, 4096
    s_mov_b32 s66, 262144
    buffer_load_dwordx4 v[192:195], v2, s[40:43], s52 offen offset:0 sc1
    buffer_load_dwordx4 v[196:199], v2, s[40:43], s52 offen offset:1024 sc1
    buffer_load_dwordx4 v[200:203], v2, s[40:43], s52 offen offset:2048 sc1
    buffer_load_dwordx4 v[204:207], v2, s[40:43], s52 offen offset:3072 sc1
    buffer_load_dwordx4 v[208:211], v2, s[40:43], s53 offen offset:0 sc1
    buffer_load_dwordx4 v[212:215], v2, s[40:43], s53 offen offset:1024 sc1
    buffer_load_dwordx4 v[216:219], v2, s[40:43], s53 offen offset:2048 sc1
    buffer_load_dwordx4 v[220:223], v2, s[40:43], s53 offen offset:3072 sc1
Lp_recurrent_sc_11:
    s_waitcnt vmcnt(7)
    v_xor_b32 v4, s30, v192
    v_bitop3_b32 v4, v4, v193, s30 bitop3:0xf6
    v_bitop3_b32 v4, v4, v194, s30 bitop3:0xf6
    v_bitop3_b32 v4, v4, v195, s30 bitop3:0xf6
    s_waitcnt vmcnt(6)
    v_bitop3_b32 v4, v4, v196, s30 bitop3:0xf6
    v_bitop3_b32 v4, v4, v197, s30 bitop3:0xf6
    v_bitop3_b32 v4, v4, v198, s30 bitop3:0xf6
    v_bitop3_b32 v4, v4, v199, s30 bitop3:0xf6
    s_waitcnt vmcnt(5)
    v_bitop3_b32 v4, v4, v200, s30 bitop3:0xf6
    v_bitop3_b32 v4, v4, v201, s30 bitop3:0xf6
    v_bitop3_b32 v4, v4, v202, s30 bitop3:0xf6
    v_bitop3_b32 v4, v4, v203, s30 bitop3:0xf6
    s_waitcnt vmcnt(4)
    v_bitop3_b32 v4, v4, v204, s30 bitop3:0xf6
    v_bitop3_b32 v4, v4, v205, s30 bitop3:0xf6
    v_bitop3_b32 v4, v4, v206, s30 bitop3:0xf6
    v_bitop3_b32 v4, v4, v207, s30 bitop3:0xf6
    s_waitcnt vmcnt(3)
    v_bitop3_b32 v4, v4, v208, s30 bitop3:0xf6
    v_bitop3_b32 v4, v4, v209, s30 bitop3:0xf6
    v_bitop3_b32 v4, v4, v210, s30 bitop3:0xf6
    v_bitop3_b32 v4, v4, v211, s30 bitop3:0xf6
    s_waitcnt vmcnt(2)
    v_bitop3_b32 v4, v4, v212, s30 bitop3:0xf6
    v_bitop3_b32 v4, v4, v213, s30 bitop3:0xf6
    v_bitop3_b32 v4, v4, v214, s30 bitop3:0xf6
    v_bitop3_b32 v4, v4, v215, s30 bitop3:0xf6
    s_waitcnt vmcnt(1)
    v_bitop3_b32 v4, v4, v216, s30 bitop3:0xf6
    v_bitop3_b32 v4, v4, v217, s30 bitop3:0xf6
    v_bitop3_b32 v4, v4, v218, s30 bitop3:0xf6
    v_bitop3_b32 v4, v4, v219, s30 bitop3:0xf6
    s_waitcnt vmcnt(0)
    v_bitop3_b32 v4, v4, v220, s30 bitop3:0xf6
    v_bitop3_b32 v4, v4, v221, s30 bitop3:0xf6
    v_bitop3_b32 v4, v4, v222, s30 bitop3:0xf6
    v_bitop3_b32 v4, v4, v223, s30 bitop3:0xf6
    v_and_b32 v4, 0xffff, v4
    v_cmp_ne_u32 vcc, 0, v4
    s_and_b64 exec, exec, vcc
    s_cbranch_scc0 Ld_recurrent_sc_12
    s_sub_u32 s66, s66, 1
    s_cbranch_scc1 Ld_recurrent_sc_12
    buffer_load_dwordx4 v[192:195], v2, s[40:43], s52 offen offset:0 sc1
    buffer_load_dwordx4 v[196:199], v2, s[40:43], s52 offen offset:1024 sc1
    buffer_load_dwordx4 v[200:203], v2, s[40:43], s52 offen offset:2048 sc1
    buffer_load_dwordx4 v[204:207], v2, s[40:43], s52 offen offset:3072 sc1
    buffer_load_dwordx4 v[208:211], v2, s[40:43], s53 offen offset:0 sc1
    buffer_load_dwordx4 v[212:215], v2, s[40:43], s53 offen offset:1024 sc1
    buffer_load_dwordx4 v[216:219], v2, s[40:43], s53 offen offset:2048 sc1
    buffer_load_dwordx4 v[220:223], v2, s[40:43], s53 offen offset:3072 sc1
    s_branch Lp_recurrent_sc_11
Ld_recurrent_sc_12:
    s_mov_b64 exec, -1
    s_mul_i32 s54, s54, 4224
    v_lshl_add_u32 v4, v1, 3, s54
    v_perm_b32 v192, v193, v192, s63
    v_perm_b32 v193, v195, v194, s63
    ds_write_b64 v4, v[192:193] offset:6144
    v_perm_b32 v196, v197, v196, s63
    v_perm_b32 v197, v199, v198, s63
    ds_write_b64 v4, v[196:197] offset:6656
    v_perm_b32 v200, v201, v200, s63
    v_perm_b32 v201, v203, v202, s63
    ds_write_b64 v4, v[200:201] offset:7200
    v_perm_b32 v204, v205, v204, s63
    v_perm_b32 v205, v207, v206, s63
    ds_write_b64 v4, v[204:205] offset:7712
    v_perm_b32 v208, v209, v208, s63
    v_perm_b32 v209, v211, v210, s63
    ds_write_b64 v4, v[208:209] offset:8256
    v_perm_b32 v212, v213, v212, s63
    v_perm_b32 v213, v215, v214, s63
    ds_write_b64 v4, v[212:213] offset:8768
    v_perm_b32 v216, v217, v216, s63
    v_perm_b32 v217, v219, v218, s63
    ds_write_b64 v4, v[216:217] offset:9312
    v_perm_b32 v220, v221, v220, s63
    v_perm_b32 v221, v223, v222, s63
    ds_write_b64 v4, v[220:221] offset:9824
    s_waitcnt lgkmcnt(0)
    s_setprio 0
    s_barrier
    s_cmp_eq_u32 s3, 7
    s_cbranch_scc1 L_hb2
    s_cmp_eq_u32 s3, 4
    s_cbranch_scc0 L_hb1
    s_lshl_b32 s52, s36, 10
    s_add_u32 s53, s52, 589824
    buffer_load_dwordx4 v[80:83], v2, s[40:43], s53 offen sc1
    s_add_u32 s53, s58, 0
    buffer_load_dwordx4 v[16:19], v11, s[44:47], s53 offen nt
    s_add_u32 s53, s58, 131072
    buffer_load_dwordx4 v[20:23], v11, s[44:47], s53 offen nt
    s_add_u32 s53, s58, 262144
    buffer_load_dwordx4 v[24:27], v11, s[44:47], s53 offen nt
    s_add_u32 s53, s58, 393216
    buffer_load_dwordx4 v[28:31], v11, s[44:47], s53 offen nt
    s_add_u32 s53, s58, 8192
    buffer_load_dwordx4 v[32:35], v11, s[44:47], s53 offen nt
    s_add_u32 s53, s58, 139264
    buffer_load_dwordx4 v[36:39], v11, s[44:47], s53 offen nt
    s_add_u32 s53, s58, 270336
    buffer_load_dwordx4 v[40:43], v11, s[44:47], s53 offen nt
    s_add_u32 s53, s58, 401408
    buffer_load_dwordx4 v[44:47], v11, s[44:47], s53 offen nt
    s_add_u32 s53, s58, 16384
    buffer_load_dwordx4 v[48:51], v11, s[44:47], s53 offen nt
    s_add_u32 s53, s58, 147456
    buffer_load_dwordx4 v[52:55], v11, s[44:47], s53 offen nt
    s_add_u32 s53, s58, 278528
    buffer_load_dwordx4 v[56:59], v11, s[44:47], s53 offen nt
    s_add_u32 s53, s58, 409600
    buffer_load_dwordx4 v[60:63], v11, s[44:47], s53 offen nt
    s_add_u32 s53, s58, 24576
    buffer_load_dwordx4 v[64:67], v11, s[44:47], s53 offen nt
    s_add_u32 s53, s58, 155648
    buffer_load_dwordx4 v[68:71], v11, s[44:47], s53 offen nt
    s_add_u32 s53, s58, 286720
    buffer_load_dwordx4 v[72:75], v11, s[44:47], s53 offen nt
    s_add_u32 s53, s58, 417792
    buffer_load_dwordx4 v[76:79], v11, s[44:47], s53 offen nt
    s_branch L_hb2
L_hb1:
    s_cmp_lt_u32 s32, 5
    s_cbranch_scc1 Lb_recurrent_sc_13
    s_cmp_ge_u32 s37, 27
    s_cbranch_scc1 Lb_recurrent_sc_13
    s_lshl_b32 s52, s31, 13
    s_add_u32 s52, s52, 327680
    s_add_u32 s53, s52, 4096
    buffer_load_dwordx4 v[80:83], v2, s[40:43], s52 offen offset:0 sc1
    buffer_load_dwordx4 v[84:87], v2, s[40:43], s52 offen offset:1024 sc1
    buffer_load_dwordx4 v[88:91], v2, s[40:43], s52 offen offset:2048 sc1
    buffer_load_dwordx4 v[92:95], v2, s[40:43], s52 offen offset:3072 sc1
    buffer_load_dwordx4 v[96:99], v2, s[40:43], s53 offen offset:0 sc1
    buffer_load_dwordx4 v[100:103], v2, s[40:43], s53 offen offset:1024 sc1
    buffer_load_dwordx4 v[104:107], v2, s[40:43], s53 offen offset:2048 sc1
    buffer_load_dwordx4 v[108:111], v2, s[40:43], s53 offen offset:3072 sc1
Lb_recurrent_sc_13:
    s_add_u32 s53, s58, 0
    buffer_load_dwordx4 v[16:19], v11, s[44:47], s53 offen nt
    s_add_u32 s53, s58, 1280
    buffer_load_dwordx4 v[20:23], v11, s[44:47], s53 offen nt
    s_add_u32 s53, s58, 2560
    buffer_load_dwordx4 v[24:27], v11, s[44:47], s53 offen nt
    s_add_u32 s53, s58, 3840
    buffer_load_dwordx4 v[28:31], v11, s[44:47], s53 offen nt
L_hb2:
    ds_read_b64_tr_b16 v[144:145], v9 offset:0
    ds_read_b64_tr_b16 v[148:149], v9 offset:33792
    ds_read_b64_tr_b16 v[152:153], v10 offset:0
    ds_read_b64_tr_b16 v[156:157], v10 offset:33792
    ds_read_b64_tr_b16 v[160:161], v9 offset:32
    ds_read_b64_tr_b16 v[164:165], v9 offset:33824
    ds_read_b64_tr_b16 v[168:169], v10 offset:32
    ds_read_b64_tr_b16 v[172:173], v10 offset:33824
    ds_read_b64_tr_b16 v[176:177], v9 offset:64
    ds_read_b64_tr_b16 v[180:181], v9 offset:33856
    ds_read_b64_tr_b16 v[184:185], v10 offset:64
    ds_read_b64_tr_b16 v[188:189], v10 offset:33856
    s_waitcnt lgkmcnt(8)
    ds_read_b64_tr_b16 v[192:193], v9 offset:96
    ds_read_b64_tr_b16 v[196:197], v9 offset:33888
    ds_read_b64_tr_b16 v[200:201], v10 offset:96
    ds_read_b64_tr_b16 v[204:205], v10 offset:33888
    v_and_b32 v4, 15, v1
    v_lshlrev_b32 v6, 2, v4
    s_waitcnt lgkmcnt(0)
    s_barrier
    s_sub_u32 s52, s3, 5
    s_cmp_lt_u32 s52, 2
    s_cbranch_scc0 Lb_recurrent_sc_14
    s_add_u32 s53, s58, 5120
    buffer_load_dwordx4 v[32:35], v11, s[44:47], s53 offen nt
    s_add_u32 s53, s58, 6400
    buffer_load_dwordx4 v[36:39], v11, s[44:47], s53 offen nt
    s_add_u32 s53, s58, 7680
    buffer_load_dwordx4 v[40:43], v11, s[44:47], s53 offen nt
    s_add_u32 s53, s58, 8960
    buffer_load_dwordx4 v[44:47], v11, s[44:47], s53 offen nt
    s_add_u32 s53, s58, 10240
    buffer_load_dwordx4 v[48:51], v11, s[44:47], s53 offen nt
    s_add_u32 s53, s58, 11520
    buffer_load_dwordx4 v[52:55], v11, s[44:47], s53 offen nt
Lb_recurrent_sc_14:
    ds_read_b32 v8, v6 offset:4096
    ds_read_b64_tr_b16 v[146:147], v9 offset:16896
    ds_read_b64_tr_b16 v[150:151], v9 offset:50688
    ds_read_b64_tr_b16 v[154:155], v10 offset:16896
    ds_read_b64_tr_b16 v[158:159], v10 offset:50688
    ds_read_b64_tr_b16 v[162:163], v9 offset:16928
    ds_read_b64_tr_b16 v[166:167], v9 offset:50720
    ds_read_b64_tr_b16 v[170:171], v10 offset:16928
    ds_read_b64_tr_b16 v[174:175], v10 offset:50720
    ds_read_b64_tr_b16 v[178:179], v9 offset:16960
    ds_read_b64_tr_b16 v[182:183], v9 offset:50752
    ds_read_b64_tr_b16 v[186:187], v10 offset:16960
    ds_read_b64_tr_b16 v[190:191], v10 offset:50752
    s_waitcnt lgkmcnt(8)
    ds_read_b64_tr_b16 v[194:195], v9 offset:16992
    ds_read_b64_tr_b16 v[198:199], v9 offset:50784
    ds_read_b64_tr_b16 v[202:203], v10 offset:16992
    ds_read_b64_tr_b16 v[206:207], v10 offset:50784
    s_waitcnt lgkmcnt(8)
L_bar3:
    s_barrier
    ds_read_b128 v[208:211], v2 offset:0
    ds_read_b128 v[212:215], v2 offset:1024
    ds_read_b128 v[216:219], v2 offset:2048
    ds_read_b128 v[220:223], v2 offset:3072
    s_add_u32 s53, s39, 131072
    s_add_u32 s54, s39, 262144
    s_add_u32 s55, s39, 393216
    v_mov_b32 v4, s67
    s_mov_b32 s52, 0xfffefffe
    s_waitcnt lgkmcnt(3)
    v_mfma_f32_16x16x32_bf16 v[224:227], v[208:211], v[144:147], 0
    v_mfma_f32_16x16x32_bf16 v[228:231], v[208:211], v[160:163], 0
    v_mfma_f32_16x16x32_bf16 v[232:235], v[208:211], v[176:179], 0
    v_mfma_f32_16x16x32_bf16 v[236:239], v[208:211], v[192:195], 0
    s_waitcnt lgkmcnt(2)
    v_mfma_f32_16x16x32_bf16 v[224:227], v[212:215], v[148:151], v[224:227]
    v_mfma_f32_16x16x32_bf16 v[228:231], v[212:215], v[164:167], v[228:231]
    v_mfma_f32_16x16x32_bf16 v[232:235], v[212:215], v[180:183], v[232:235]
    v_mfma_f32_16x16x32_bf16 v[236:239], v[212:215], v[196:199], v[236:239]
    s_waitcnt lgkmcnt(1)
    v_mfma_f32_16x16x32_bf16 v[224:227], v[216:219], v[152:155], v[224:227]
    v_mfma_f32_16x16x32_bf16 v[228:231], v[216:219], v[168:171], v[228:231]
    v_mfma_f32_16x16x32_bf16 v[232:235], v[216:219], v[184:187], v[232:235]
    v_mfma_f32_16x16x32_bf16 v[236:239], v[216:219], v[200:203], v[236:239]
    s_waitcnt lgkmcnt(0)
    v_mfma_f32_16x16x32_bf16 v[224:227], v[220:223], v[156:159], v[224:227]
    v_mfma_f32_16x16x32_bf16 v[228:231], v[220:223], v[172:175], v[228:231]
    v_mfma_f32_16x16x32_bf16 v[232:235], v[220:223], v[188:191], v[232:235]
    v_mfma_f32_16x16x32_bf16 v[236:239], v[220:223], v[204:207], v[236:239]
    s_nop 5
    v_cvt_pk_bf16_f32 v240, v224, v228
    v_cvt_pk_bf16_f32 v242, v225, v229
    v_cvt_pk_bf16_f32 v244, v226, v230
    v_cvt_pk_bf16_f32 v246, v227, v231
    v_and_or_b32 v240, v240, s52, v4
    v_and_or_b32 v242, v242, s52, v4
    v_and_or_b32 v244, v244, s52, v4
    v_and_or_b32 v246, v246, s52, v4
    v_cvt_pk_bf16_f32 v241, v232, v236
    v_and_or_b32 v241, v241, s52, v4
    buffer_store_dwordx2 v[240:241], v13, s[40:43], s39 offen sc1
    v_cvt_pk_bf16_f32 v243, v233, v237
    v_and_or_b32 v243, v243, s52, v4
    buffer_store_dwordx2 v[242:243], v13, s[40:43], s53 offen sc1
    v_cvt_pk_bf16_f32 v245, v234, v238
    v_and_or_b32 v245, v245, s52, v4
    buffer_store_dwordx2 v[244:245], v13, s[40:43], s54 offen sc1
    v_cvt_pk_bf16_f32 v247, v235, v239
    v_and_or_b32 v247, v247, s52, v4
    buffer_store_dwordx2 v[246:247], v13, s[40:43], s55 offen sc1
    s_cmp_eq_u32 s3, 7
    s_cbranch_scc0 Lb_recurrent_sc_15
    v_mov_b32 v20, 0x3f803f80
    v_mov_b32 v21, 0x3f803f80
    v_mov_b32 v22, 0x3f803f80
    v_mov_b32 v23, 0x3f803f80
    v_mul_f32 v16, 0x3e0293ee, v8
    v_mov_b32 v17, s30
    v_mfma_f32_16x16x32_bf16 v[24:27], v[20:23], v[208:211], 0
    v_mfma_f32_16x16x32_bf16 v[24:27], v[20:23], v[212:215], v[24:27]
    v_mfma_f32_16x16x32_bf16 v[24:27], v[20:23], v[216:219], v[24:27]
    v_mfma_f32_16x16x32_bf16 v[24:27], v[20:23], v[220:223], v[24:27]
    v_mov_b32 v19, s30
    v_and_b32 v4, 7, v1
    v_lshlrev_b32 v4, 5, v4
    v_bfe_u32 v5, v1, 3, 1
    v_lshl_add_u32 v4, v5, 4, v4
    s_lshl_b32 s52, s33, 1
    s_add_u32 s52, s52, s34
    s_lshl_b32 s52, s52, 8
    s_add_u32 s52, s52, 1769472
    v_mov_b32 v18, v24
    s_mov_b64 exec, 0xffff
    buffer_store_dwordx4 v[16:19], v4, s[40:43], s52 offen sc1
    s_mov_b64 exec, -1
Lb_recurrent_sc_15:
    s_sub_u32 s52, s3, 5
    s_cmp_lt_u32 s52, 2
    s_cbranch_scc0 Lb_recurrent_sc_16
    s_add_u32 s53, s58, 12800
    buffer_load_dwordx4 v[56:59], v11, s[44:47], s53 offen nt
    s_add_u32 s53, s58, 14080
    buffer_load_dwordx4 v[60:63], v11, s[44:47], s53 offen nt
    s_add_u32 s53, s58, 15360
    buffer_load_dwordx4 v[64:67], v11, s[44:47], s53 offen nt
    s_add_u32 s53, s58, 16640
    buffer_load_dwordx4 v[68:71], v11, s[44:47], s53 offen nt
    s_add_u32 s53, s58, 17920
    buffer_load_dwordx4 v[72:75], v11, s[44:47], s53 offen nt
    s_add_u32 s53, s58, 19200
    buffer_load_dwordx4 v[76:79], v11, s[44:47], s53 offen nt
    s_cmp_lt_u32 s32, 5
    s_cbranch_scc1 Lb_recurrent_sc_17
    s_cmp_ge_u32 s37, 27
    s_cbranch_scc1 Lb_recurrent_sc_17
    s_lshl_b32 s52, s31, 13
    s_add_u32 s52, s52, 327680
    s_add_u32 s53, s52, 4096
    s_sub_u32 s54, s3, 5
    s_lshl_b32 s55, s54, 9
    s_add_u32 s57, s55, 4608
    v_and_b32 v6, 31, v1
    v_lshlrev_b32 v6, 4, v6
    v_lshrrev_b32 v5, 5, v1
    v_lshl_add_u32 v6, v5, 3, v6
    v_add_u32 v6, s57, v6
    s_mov_b32 s66, 262144
    s_waitcnt vmcnt(20)
Lp_recurrent_sc_18:
    v_xor_b32 v80, s68, v80
    v_xor_b32 v81, s68, v81
    v_xor_b32 v82, s68, v82
    v_xor_b32 v83, s68, v83
    v_or3_b32 v4, v80, v81, v82
    v_or_b32 v4, v4, v83
    v_xor_b32 v84, s68, v84
    v_xor_b32 v85, s68, v85
    v_xor_b32 v86, s68, v86
    v_xor_b32 v87, s68, v87
    v_or3_b32 v4, v4, v84, v85
    v_or3_b32 v4, v4, v86, v87
    v_xor_b32 v88, s68, v88
    v_xor_b32 v89, s68, v89
    v_xor_b32 v90, s68, v90
    v_xor_b32 v91, s68, v91
    v_or3_b32 v4, v4, v88, v89
    v_or3_b32 v4, v4, v90, v91
    v_xor_b32 v92, s68, v92
    v_xor_b32 v93, s68, v93
    v_xor_b32 v94, s68, v94
    v_xor_b32 v95, s68, v95
    v_or3_b32 v4, v4, v92, v93
    v_or3_b32 v4, v4, v94, v95
    v_xor_b32 v96, s68, v96
    v_xor_b32 v97, s68, v97
    v_xor_b32 v98, s68, v98
    v_xor_b32 v99, s68, v99
    v_or3_b32 v4, v4, v96, v97
    v_or3_b32 v4, v4, v98, v99
    v_xor_b32 v100, s68, v100
    v_xor_b32 v101, s68, v101
    v_xor_b32 v102, s68, v102
    v_xor_b32 v103, s68, v103
    v_or3_b32 v4, v4, v100, v101
    v_or3_b32 v4, v4, v102, v103
    v_xor_b32 v104, s68, v104
    v_xor_b32 v105, s68, v105
    v_xor_b32 v106, s68, v106
    v_xor_b32 v107, s68, v107
    v_or3_b32 v4, v4, v104, v105
    v_or3_b32 v4, v4, v106, v107
    v_xor_b32 v108, s68, v108
    v_xor_b32 v109, s68, v109
    v_xor_b32 v110, s68, v110
    v_xor_b32 v111, s68, v111
    v_or3_b32 v4, v4, v108, v109
    v_or3_b32 v4, v4, v110, v111
    v_and_b32 v4, 255, v4
    v_cmp_ne_u32 vcc, 0, v4
    s_and_b64 exec, exec, vcc
    s_cbranch_scc0 Ld_recurrent_sc_19
    s_sub_u32 s66, s66, 1
    s_cbranch_scc1 Ld_recurrent_sc_19
    buffer_load_dwordx4 v[80:83], v2, s[40:43], s52 offen offset:0 sc1
    buffer_load_dwordx4 v[84:87], v2, s[40:43], s52 offen offset:1024 sc1
    buffer_load_dwordx4 v[88:91], v2, s[40:43], s52 offen offset:2048 sc1
    buffer_load_dwordx4 v[92:95], v2, s[40:43], s52 offen offset:3072 sc1
    buffer_load_dwordx4 v[96:99], v2, s[40:43], s53 offen offset:0 sc1
    buffer_load_dwordx4 v[100:103], v2, s[40:43], s53 offen offset:1024 sc1
    buffer_load_dwordx4 v[104:107], v2, s[40:43], s53 offen offset:2048 sc1
    buffer_load_dwordx4 v[108:111], v2, s[40:43], s53 offen offset:3072 sc1
    s_waitcnt vmcnt(0)
    s_branch Lp_recurrent_sc_18
Ld_recurrent_sc_19:
    s_mov_b64 exec, -1
    v_pk_add_f32 v[80:81], v[80:81], v[96:97]
    v_pk_add_f32 v[82:83], v[82:83], v[98:99]
    v_pk_add_f32 v[84:85], v[84:85], v[100:101]
    v_pk_add_f32 v[86:87], v[86:87], v[102:103]
    v_pk_add_f32 v[88:89], v[88:89], v[104:105]
    v_pk_add_f32 v[90:91], v[90:91], v[106:107]
    v_pk_add_f32 v[92:93], v[92:93], v[108:109]
    v_pk_add_f32 v[94:95], v[94:95], v[110:111]
    v_pk_add_f32 v[80:81], v[80:81], v[88:89]
    v_pk_add_f32 v[82:83], v[82:83], v[90:91]
    v_pk_add_f32 v[84:85], v[84:85], v[92:93]
    v_pk_add_f32 v[86:87], v[86:87], v[94:95]
    v_pk_add_f32 v[80:81], v[80:81], v[84:85]
    v_pk_add_f32 v[82:83], v[82:83], v[86:87]
    v_cvt_pk_bf16_f32 v80, v80, v80
    v_and_b32 v80, s65, v80
    v_cvt_pk_bf16_f32 v81, v81, v81
    v_and_b32 v81, s65, v81
    v_cvt_pk_bf16_f32 v82, v82, v82
    v_and_b32 v82, s65, v82
    v_cvt_pk_bf16_f32 v83, v83, v83
    v_and_b32 v83, s65, v83
    v_mul_f32 v84, v80, v80
    v_mul_f32 v85, v81, v81
    v_mul_f32 v86, v82, v82
    v_mul_f32 v87, v83, v83
    s_mov_b32 s54, 0x3d372713
    v_fma_f32 v84, v84, s54, 1.0
    v_fma_f32 v85, v85, s54, 1.0
    v_fma_f32 v86, v86, s54, 1.0
    v_fma_f32 v87, v87, s54, 1.0
    v_mul_f32 v84, v84, v80
    v_mul_f32 v85, v85, v81
    v_mul_f32 v86, v86, v82
    v_mul_f32 v87, v87, v83
    v_mul_f32 v84, 0xc0135761, v84
    v_mul_f32 v85, 0xc0135761, v85
    v_mul_f32 v86, 0xc0135761, v86
    v_mul_f32 v87, 0xc0135761, v87
    v_exp_f32 v84, v84
    v_exp_f32 v85, v85
    v_exp_f32 v86, v86
    v_exp_f32 v87, v87
    v_add_f32 v84, 1.0, v84
    v_add_f32 v85, 1.0, v85
    v_add_f32 v86, 1.0, v86
    v_add_f32 v87, 1.0, v87
    v_rcp_f32 v84, v84
    v_rcp_f32 v85, v85
    v_rcp_f32 v86, v86
    v_rcp_f32 v87, v87
    v_mul_f32 v84, v84, v80
    v_mul_f32 v85, v85, v81
    v_mul_f32 v86, v86, v82
    v_mul_f32 v87, v87, v83
    v_cvt_pk_bf16_f32 v84, v84, v84
    v_and_b32 v84, s65, v84
    v_cvt_pk_bf16_f32 v85, v85, v85
    v_and_b32 v85, s65, v85
    v_cvt_pk_bf16_f32 v86, v86, v86
    v_and_b32 v86, s65, v86
    v_cvt_pk_bf16_f32 v87, v87, v87
    v_and_b32 v87, s65, v87
    v_mul_f32_dpp v84, v80, v84 row_ror:8 row_mask:0xf bank_mask:0xf
    v_mul_f32_dpp v85, v81, v85 row_ror:8 row_mask:0xf bank_mask:0xf
    v_mul_f32_dpp v86, v82, v86 row_ror:8 row_mask:0xf bank_mask:0xf
    v_mul_f32_dpp v87, v83, v87 row_ror:8 row_mask:0xf bank_mask:0xf
    v_cvt_pk_bf16_f32 v80, v84, v85
    v_cvt_pk_bf16_f32 v81, v86, v87
    ds_write_b64 v6, v[80:81]
Lb_recurrent_sc_17:
Lb_recurrent_sc_16:
    s_lshl_b32 s56, s36, 3
    s_add_u32 s56, s56, s3
    s_lshl_b32 s56, s56, 11
    s_add_u32 s56, s56, 3145728
    s_and_b32 s54, s31, 16
    s_lshl_b32 s55, s69, 1
    s_add_u32 s54, s54, s55
    s_bfe_u32 s55, s31, 0x10003
    s_add_u32 s54, s54, s55
    s_lshl_b32 s54, s54, 4
    s_lshl_b32 s55, s3, 13
    s_add_u32 s54, s54, s55
    s_add_u32 s54, s54, 1769472
    s_add_u32 s55, s54, 4096
    v_lshrrev_b32 v5, 3, v1
    v_lshlrev_b32 v5, 9, v5
    v_mov_b32 v7, 0x8000
    s_mul_i32 s52, s3, 144
    v_mov_b32 v12, s52
    v_and_b32 v6, 7, v1
    v_lshl_add_u32 v6, v6, 4, v12
    v_lshrrev_b32 v4, 4, v1
    v_lshl_add_u32 v6, v4, 2, v6
    s_waitcnt vmcnt(0)
    s_barrier
    s_mov_b32 s66, 262144
    buffer_load_dwordx4 v[192:195], v2, s[40:43], s56 offen offset:0 sc1
    buffer_load_dwordx4 v[196:199], v2, s[40:43], s56 offen offset:1024 sc1
    buffer_load_dwordx4 v[200:203], v5, s[40:43], s54 offen sc1
    buffer_load_dwordx4 v[204:207], v5, s[40:43], s55 offen sc1
    s_sub_u32 s52, s3, 4
    s_cmp_lt_u32 s52, 3
    s_cbranch_scc0 Lb_recurrent_sc_22
    v_perm_b32 v80, v20, v16, s62
    v_perm_b32 v81, v28, v24, s62
    v_perm_b32 v82, v36, v32, s62
    v_perm_b32 v83, v44, v40, s62
    v_perm_b32 v84, v20, v16, s63
    v_perm_b32 v85, v28, v24, s63
    v_perm_b32 v86, v36, v32, s63
    v_perm_b32 v87, v44, v40, s63
    v_perm_b32 v88, v21, v17, s62
    v_perm_b32 v89, v29, v25, s62
    v_perm_b32 v90, v37, v33, s62
    v_perm_b32 v91, v45, v41, s62
    v_perm_b32 v92, v21, v17, s63
    v_perm_b32 v93, v29, v25, s63
    v_perm_b32 v94, v37, v33, s63
    v_perm_b32 v95, v45, v41, s63
    v_perm_b32 v96, v22, v18, s62
    v_perm_b32 v97, v30, v26, s62
    v_perm_b32 v98, v38, v34, s62
    v_perm_b32 v99, v46, v42, s62
    v_perm_b32 v100, v22, v18, s63
    v_perm_b32 v101, v30, v26, s63
    v_perm_b32 v102, v38, v34, s63
    v_perm_b32 v103, v46, v42, s63
    v_perm_b32 v104, v23, v19, s62
    v_perm_b32 v105, v31, v27, s62
    v_perm_b32 v106, v39, v35, s62
    v_perm_b32 v107, v47, v43, s62
    v_perm_b32 v108, v23, v19, s63
    v_perm_b32 v109, v31, v27, s63
    v_perm_b32 v110, v39, v35, s63
    v_perm_b32 v111, v47, v43, s63
    v_perm_b32 v112, v52, v48, s62
    v_perm_b32 v113, v60, v56, s62
    v_perm_b32 v114, v68, v64, s62
    v_perm_b32 v115, v76, v72, s62
    v_perm_b32 v116, v52, v48, s63
    v_perm_b32 v117, v60, v56, s63
    v_perm_b32 v118, v68, v64, s63
    v_perm_b32 v119, v76, v72, s63
    v_perm_b32 v120, v53, v49, s62
    v_perm_b32 v121, v61, v57, s62
    v_perm_b32 v122, v69, v65, s62
    v_perm_b32 v123, v77, v73, s62
    v_perm_b32 v124, v53, v49, s63
    v_perm_b32 v125, v61, v57, s63
    v_perm_b32 v126, v69, v65, s63
    v_perm_b32 v127, v77, v73, s63
    v_perm_b32 v128, v54, v50, s62
    v_perm_b32 v129, v62, v58, s62
    v_perm_b32 v130, v70, v66, s62
    v_perm_b32 v131, v78, v74, s62
    v_perm_b32 v132, v54, v50, s63
    v_perm_b32 v133, v62, v58, s63
    v_perm_b32 v134, v70, v66, s63
    v_perm_b32 v135, v78, v74, s63
    v_perm_b32 v136, v55, v51, s62
    v_perm_b32 v137, v63, v59, s62
    v_perm_b32 v138, v71, v67, s62
    v_perm_b32 v139, v79, v75, s62
    v_perm_b32 v140, v55, v51, s63
    v_perm_b32 v141, v63, v59, s63
    v_perm_b32 v142, v71, v67, s63
    v_perm_b32 v143, v79, v75, s63
Lb_recurrent_sc_22:
Lp_recurrent_sc_20:
    s_waitcnt vmcnt(3)
    v_xor_b32 v192, s67, v192
    v_xor_b32 v193, s67, v193
    v_xor_b32 v194, s67, v194
    v_xor_b32 v195, s67, v195
    v_or3_b32 v4, v192, v193, v194
    v_or_b32 v4, v4, v195
    s_waitcnt vmcnt(2)
    v_xor_b32 v196, s67, v196
    v_xor_b32 v197, s67, v197
    v_xor_b32 v198, s67, v198
    v_xor_b32 v199, s67, v199
    v_or3_b32 v4, v4, v196, v197
    v_or3_b32 v4, v4, v198, v199
    v_and_b32 v4, 65537, v4
    s_waitcnt vmcnt(1)
    v_bitop3_b32 v4, v4, v201, s30 bitop3:0xf6
    v_bitop3_b32 v4, v4, v203, s30 bitop3:0xf6
    s_waitcnt vmcnt(0)
    v_bitop3_b32 v4, v4, v205, s30 bitop3:0xf6
    v_bitop3_b32 v4, v4, v207, s30 bitop3:0xf6
    v_cmp_ne_u32 vcc, 0, v4
    s_and_b64 vcc, exec, vcc
    s_cbranch_scc0 Ld_recurrent_sc_21
    v_or_b32_dpp v4, v4, v4 quad_perm:[1,0,3,2] row_mask:0xf bank_mask:0xf
    s_nop 1
    v_or_b32_dpp v4, v4, v4 quad_perm:[2,3,0,1] row_mask:0xf bank_mask:0xf
    s_nop 1
    v_or_b32_dpp v4, v4, v4 row_half_mirror row_mask:0xf bank_mask:0xf
    v_cmp_ne_u32 vcc, 0, v4
    s_and_b64 exec, exec, vcc
    s_sub_u32 s66, s66, 1
    s_cbranch_scc1 Ld_recurrent_sc_21
    buffer_load_dwordx4 v[192:195], v2, s[40:43], s56 offen offset:0 sc1
    buffer_load_dwordx4 v[196:199], v2, s[40:43], s56 offen offset:1024 sc1
    buffer_load_dwordx4 v[200:203], v5, s[40:43], s54 offen sc1
    buffer_load_dwordx4 v[204:207], v5, s[40:43], s55 offen sc1
    s_branch Lp_recurrent_sc_20
Ld_recurrent_sc_21:
    s_mov_b64 exec, -1
    v_max_f32 v8, v200, v204
    v_lshl_or_b32 v208, v192, 16, v7
    v_and_or_b32 v209, v192, s65, v7
    v_lshl_or_b32 v210, v193, 16, v7
    v_and_or_b32 v211, v193, s65, v7
    v_max_f32_dpp v8, v8, v8 row_ror:8 row_mask:0xf bank_mask:0xf
    v_mov_b32 v9, v8
    v_lshl_or_b32 v212, v194, 16, v7
    v_and_or_b32 v213, v194, s65, v7
    v_lshl_or_b32 v214, v195, 16, v7
    v_and_or_b32 v215, v195, s65, v7
    v_permlane16_swap_b32 v9, v8
    v_max_f32 v8, v8, v9
    v_mov_b32 v9, v8
    v_lshl_or_b32 v216, v196, 16, v7
    v_and_or_b32 v217, v196, s65, v7
    v_lshl_or_b32 v218, v197, 16, v7
    v_and_or_b32 v219, v197, s65, v7
    v_permlane32_swap_b32 v9, v8
    v_max_f32 v8, v8, v9
    v_sub_f32 v200, v200, v8
    v_sub_f32 v204, v204, v8
    v_exp_f32 v200, v200
    v_exp_f32 v204, v204
    v_lshl_or_b32 v220, v198, 16, v7
    v_and_or_b32 v221, v198, s65, v7
    v_lshl_or_b32 v222, v199, 16, v7
    v_and_or_b32 v223, v199, s65, v7
    v_mul_f32 v10, v200, v202
    v_fmac_f32 v10, v204, v206
    v_pk_mul_f32 v[208:209], v[208:209], v[200:201] op_sel_hi:[1,0]
    v_pk_mul_f32 v[210:211], v[210:211], v[200:201] op_sel_hi:[1,0]
    v_pk_mul_f32 v[212:213], v[212:213], v[200:201] op_sel_hi:[1,0]
    v_pk_mul_f32 v[214:215], v[214:215], v[200:201] op_sel_hi:[1,0]
    v_add_f32_dpp v10, v10, v10 row_ror:8 row_mask:0xf bank_mask:0xf
    v_pk_fma_f32 v[208:209], v[216:217], v[204:205], v[208:209] op_sel_hi:[1,0,1]
    v_pk_fma_f32 v[210:211], v[218:219], v[204:205], v[210:211] op_sel_hi:[1,0,1]
    v_pk_fma_f32 v[212:213], v[220:221], v[204:205], v[212:213] op_sel_hi:[1,0,1]
    v_pk_fma_f32 v[214:215], v[222:223], v[204:205], v[214:215] op_sel_hi:[1,0,1]
    v_mov_b32 v9, v10
    v_permlane32_swap_b32 v208, v212
    v_permlane32_swap_b32 v209, v213
    v_permlane32_swap_b32 v210, v214
    v_permlane32_swap_b32 v211, v215
    v_permlane32_swap_b32 v9, v10
    v_pk_add_f32 v[208:209], v[208:209], v[212:213]
    v_pk_add_f32 v[210:211], v[210:211], v[214:215]
    v_add_f32 v10, v10, v9
    v_mov_b32 v9, v10
    v_permlane16_swap_b32 v208, v210
    v_permlane16_swap_b32 v209, v211
    v_permlane16_swap_b32 v9, v10
    v_pk_add_f32 v[208:209], v[208:209], v[210:211]
    v_add_f32 v9, v10, v9
    s_nop 0
    v_add_f32_dpp v208, v208, v208 row_ror:8 row_mask:0xf bank_mask:0xf
    v_add_f32_dpp v209, v209, v209 row_ror:8 row_mask:0xf bank_mask:0xf
    ds_write_b64 v12, v[8:9] offset:6272
    v_cvt_pk_bf16_f32 v208, v208, v209
    ds_write_b32 v6, v208 offset:6144
    s_waitcnt lgkmcnt(0)
    s_barrier
    s_cmp_lt_u32 s3, 4
    s_cbranch_scc1 L_endE
    s_cmp_eq_u32 s3, 7
    s_cbranch_scc1 L_fin
    s_cmp_eq_u32 s3, 4
    s_cbranch_scc0 L_e
    v_and_b32 v4, 7, v1
    v_mul_u32_u24 v4, 144, v4
    v_lshrrev_b32 v5, 4, v1
    v_lshl_add_u32 v5, v5, 5, v4
    ds_read_b64 v[8:9], v4 offset:6272
    ds_read_b128 v[176:179], v5 offset:6144
    ds_read_b128 v[180:183], v5 offset:6160
    s_lshl_b32 s53, s36, 10
    s_add_u32 s53, s53, 589824
    v_and_b32 v6, 7, v1
    v_lshlrev_b32 v6, 4, v6
    v_bfe_u32 v7, v1, 3, 1
    v_lshl_add_u32 v6, v7, 9, v6
    v_lshrrev_b32 v7, 4, v1
    v_lshl_add_u32 v6, v7, 7, v6
    s_waitcnt lgkmcnt(1)
    v_mfma_f32_16x16x32_bf16 v[144:147], v[176:179], v[80:83], 0
    v_mfma_f32_16x16x32_bf16 v[148:151], v[176:179], v[84:87], 0
    v_mfma_f32_16x16x32_bf16 v[152:155], v[176:179], v[88:91], 0
    v_mfma_f32_16x16x32_bf16 v[156:159], v[176:179], v[92:95], 0
    v_mfma_f32_16x16x32_bf16 v[160:163], v[176:179], v[96:99], 0
    v_mfma_f32_16x16x32_bf16 v[164:167], v[176:179], v[100:103], 0
    v_mfma_f32_16x16x32_bf16 v[168:171], v[176:179], v[104:107], 0
    v_mfma_f32_16x16x32_bf16 v[172:175], v[176:179], v[108:111], 0
    s_waitcnt lgkmcnt(0)
    v_mfma_f32_16x16x32_bf16 v[144:147], v[180:183], v[112:115], v[144:147]
    v_mfma_f32_16x16x32_bf16 v[148:151], v[180:183], v[116:119], v[148:151]
    v_mfma_f32_16x16x32_bf16 v[152:155], v[180:183], v[120:123], v[152:155]
    v_mfma_f32_16x16x32_bf16 v[156:159], v[180:183], v[124:127], v[156:159]
    v_mfma_f32_16x16x32_bf16 v[160:163], v[180:183], v[128:131], v[160:163]
    v_mfma_f32_16x16x32_bf16 v[164:167], v[180:183], v[132:135], v[164:167]
    v_mfma_f32_16x16x32_bf16 v[168:171], v[180:183], v[136:139], v[168:171]
    v_mfma_f32_16x16x32_bf16 v[172:175], v[180:183], v[140:143], v[172:175]
    v_max_f32_dpp v10, v8, v8 quad_perm:[1,0,3,2] row_mask:0xf bank_mask:0xf
    s_nop 1
    v_max_f32_dpp v10, v10, v10 quad_perm:[2,3,0,1] row_mask:0xf bank_mask:0xf
    v_sub_f32 v8, v8, v10
    v_exp_f32 v8, v8
    s_nop 0
    v_mul_f32 v9, v8, v9
    s_nop 1
    v_add_f32_dpp v9, v9, v9 quad_perm:[1,0,3,2] row_mask:0xf bank_mask:0xf
    s_nop 1
    v_add_f32_dpp v9, v9, v9 quad_perm:[2,3,0,1] row_mask:0xf bank_mask:0xf
    v_rcp_f32 v9, v9
    s_nop 0
    v_mul_f32 v8, v8, v9
    s_nop 1
    v_mov_b32_dpp v184, v8 row_newbcast:0 row_mask:0x5 bank_mask:0xf
    v_mov_b32_dpp v185, v8 row_newbcast:1 row_mask:0x5 bank_mask:0xf
    v_mov_b32_dpp v186, v8 row_newbcast:2 row_mask:0x5 bank_mask:0xf
    v_mov_b32_dpp v187, v8 row_newbcast:3 row_mask:0x5 bank_mask:0xf
    v_mov_b32_dpp v184, v8 row_newbcast:4 row_mask:0xa bank_mask:0xf
    v_mov_b32_dpp v185, v8 row_newbcast:5 row_mask:0xa bank_mask:0xf
    v_mov_b32_dpp v186, v8 row_newbcast:6 row_mask:0xa bank_mask:0xf
    v_mov_b32_dpp v187, v8 row_newbcast:7 row_mask:0xa bank_mask:0xf
    v_pk_mul_f32 v[144:145], v[144:145], v[184:185]
    v_pk_mul_f32 v[148:149], v[148:149], v[184:185]
    v_pk_mul_f32 v[152:153], v[152:153], v[184:185]
    v_pk_mul_f32 v[156:157], v[156:157], v[184:185]
    v_pk_mul_f32 v[160:161], v[160:161], v[184:185]
    v_pk_mul_f32 v[164:165], v[164:165], v[184:185]
    v_pk_mul_f32 v[168:169], v[168:169], v[184:185]
    v_pk_mul_f32 v[172:173], v[172:173], v[184:185]
    v_pk_fma_f32 v[144:145], v[146:147], v[186:187], v[144:145]
    v_pk_fma_f32 v[148:149], v[150:151], v[186:187], v[148:149]
    v_pk_fma_f32 v[152:153], v[154:155], v[186:187], v[152:153]
    v_pk_fma_f32 v[156:157], v[158:159], v[186:187], v[156:157]
    v_pk_fma_f32 v[160:161], v[162:163], v[186:187], v[160:161]
    v_pk_fma_f32 v[164:165], v[166:167], v[186:187], v[164:165]
    v_pk_fma_f32 v[168:169], v[170:171], v[186:187], v[168:169]
    v_pk_fma_f32 v[172:173], v[174:175], v[186:187], v[172:173]
    v_add_f32 v144, v144, v145
    v_add_f32 v148, v148, v149
    v_add_f32 v152, v152, v153
    v_add_f32 v156, v156, v157
    v_add_f32 v160, v160, v161
    v_add_f32 v164, v164, v165
    v_add_f32 v168, v168, v169
    v_add_f32 v172, v172, v173
    v_cndmask_b32 v12, v144, v160, s[60:61]
    v_cndmask_b32 v13, v148, v164, s[60:61]
    v_cndmask_b32 v14, v152, v168, s[60:61]
    v_cndmask_b32 v15, v156, v172, s[60:61]
    v_and_or_b32 v12, v12, s64, v3
    v_and_or_b32 v13, v13, s64, v3
    v_and_or_b32 v14, v14, s64, v3
    v_and_or_b32 v15, v15, s64, v3
    buffer_store_dwordx4 v[12:15], v6, s[40:43], s53 offen
    s_add_u32 s53, s53, 786432
    v_mov_b32 v4, 0
Lw_recurrent_sc_23:
    s_sleep 1
    ds_read_b32 v5, v4 offset:4376
    s_waitcnt lgkmcnt(0)
    v_readfirstlane_b32 s52, v5
    s_cmp_ge_u32 s52, 2
    s_cbranch_scc0 Lw_recurrent_sc_23
    buffer_store_dwordx4 v[12:15], v6, s[40:43], s53 offen sc1
    s_endpgm
L_e:
    s_sub_u32 s54, s3, 5
    s_lshl_b32 s55, s54, 9
    s_add_u32 s57, s55, 4608
    v_bfe_u32 v4, v1, 2, 1
    v_lshlrev_b32 v4, 8, v4
    v_lshrrev_b32 v5, 4, v1
    v_lshl_add_u32 v4, v5, 5, v4
    v_add_u32 v10, s57, v4
    s_lshl_b32 s59, s31, 13
    s_cmp_lt_u32 s32, 5
    s_cbranch_scc1 L_e1
    s_cmp_ge_u32 s37, 27
    s_cbranch_scc1 L_endE2
    s_lshl_b32 s56, s38, 5
    s_add_u32 s56, s56, s37
    s_lshl_b32 s56, s56, 10
    s_add_u32 s56, s56, 2162688
    s_branch L_e2
L_e1:
    s_add_u32 s59, s59, 589824
    s_add_u32 s59, s59, s55
    v_and_b32 v5, 31, v1
    v_lshlrev_b32 v5, 4, v5
    v_lshrrev_b32 v6, 5, v1
    v_lshl_add_u32 v5, v6, 10, v5
    v_and_b32 v7, 7, v1
    v_lshlrev_b32 v7, 4, v7
    v_lshl_add_u32 v7, v6, 2, v7
    v_bfe_u32 v6, v1, 3, 1
    v_lshl_add_u32 v7, v6, 8, v7
    v_bfe_u32 v6, v1, 4, 1
    v_lshl_add_u32 v7, v6, 3, v7
    v_add_u32 v7, s57, v7
    s_lshl_b32 s54, s38, 6
    s_add_u32 s54, s54, s37
    s_lshl_b32 s54, s54, 10
    s_add_u32 s56, s54, 1835008
    s_mov_b32 s66, 262144
    s_cmp_eq_u32 s66, 262120
    s_cbranch_scc0 Lb_recurrent_sc_26
    s_mov_b64 s[72:73], exec
    s_mov_b64 exec, 1
    v_mov_b32 v4, 0
    v_mov_b32 v14, 1
    ds_add_u32 v4, v14 offset:4376
    s_mov_b64 exec, -1
    s_mov_b64 exec, s[72:73]
Lb_recurrent_sc_26:
    s_cmp_gt_u32 s66, 262120
    s_cselect_b32 s52, 0, 786432
    s_add_u32 s52, s52, s59
    s_add_u32 s53, s52, 4096
    buffer_load_dwordx4 v[192:195], v5, s[40:43], s52 offen offset:0 sc1
    buffer_load_dwordx4 v[196:199], v5, s[40:43], s52 offen offset:2048 sc1
    buffer_load_dwordx4 v[200:203], v5, s[40:43], s53 offen offset:0 sc1
    buffer_load_dwordx4 v[204:207], v5, s[40:43], s53 offen offset:2048 sc1
Lp_recurrent_sc_24:
    s_waitcnt vmcnt(3)
    v_xor_b32 v192, s68, v192
    v_xor_b32 v193, s68, v193
    v_xor_b32 v194, s68, v194
    v_xor_b32 v195, s68, v195
    v_or3_b32 v4, v192, v193, v194
    v_or_b32 v4, v4, v195
    s_waitcnt vmcnt(2)
    v_xor_b32 v196, s68, v196
    v_xor_b32 v197, s68, v197
    v_xor_b32 v198, s68, v198
    v_xor_b32 v199, s68, v199
    v_or3_b32 v4, v4, v196, v197
    v_or3_b32 v4, v4, v198, v199
    s_waitcnt vmcnt(1)
    v_xor_b32 v200, s68, v200
    v_xor_b32 v201, s68, v201
    v_xor_b32 v202, s68, v202
    v_xor_b32 v203, s68, v203
    v_or3_b32 v4, v4, v200, v201
    v_or3_b32 v4, v4, v202, v203
    s_waitcnt vmcnt(0)
    v_xor_b32 v204, s68, v204
    v_xor_b32 v205, s68, v205
    v_xor_b32 v206, s68, v206
    v_xor_b32 v207, s68, v207
    v_or3_b32 v4, v4, v204, v205
    v_or3_b32 v4, v4, v206, v207
    v_and_b32 v4, 255, v4
    v_cmp_ne_u32 vcc, 0, v4
    s_and_b64 exec, exec, vcc
    s_cbranch_scc0 Ld_recurrent_sc_25
    s_sub_u32 s66, s66, 1
    s_cbranch_scc1 Ld_recurrent_sc_25
    s_cmp_eq_u32 s66, 262120
    s_cbranch_scc0 Lb_recurrent_sc_27
    s_mov_b64 s[72:73], exec
    s_mov_b64 exec, 1
    v_mov_b32 v4, 0
    v_mov_b32 v14, 1
    ds_add_u32 v4, v14 offset:4376
    s_mov_b64 exec, -1
    s_mov_b64 exec, s[72:73]
Lb_recurrent_sc_27:
    s_cmp_gt_u32 s66, 262120
    s_cselect_b32 s52, 0, 786432
    s_add_u32 s52, s52, s59
    s_add_u32 s53, s52, 4096
    buffer_load_dwordx4 v[192:195], v5, s[40:43], s52 offen offset:0 sc1
    buffer_load_dwordx4 v[196:199], v5, s[40:43], s52 offen offset:2048 sc1
    buffer_load_dwordx4 v[200:203], v5, s[40:43], s53 offen offset:0 sc1
    buffer_load_dwordx4 v[204:207], v5, s[40:43], s53 offen offset:2048 sc1
    s_branch Lp_recurrent_sc_24
Ld_recurrent_sc_25:
    s_mov_b64 exec, -1
    v_pk_add_f32 v[192:193], v[192:193], v[200:201]
    v_pk_add_f32 v[194:195], v[194:195], v[202:203]
    v_pk_add_f32 v[196:197], v[196:197], v[204:205]
    v_pk_add_f32 v[198:199], v[198:199], v[206:207]
    v_pk_add_f32 v[192:193], v[192:193], v[196:197]
    v_pk_add_f32 v[194:195], v[194:195], v[198:199]
    s_nop 1
    v_permlane32_swap_b32 v192, v194
    v_permlane32_swap_b32 v193, v195
    v_pk_add_f32 v[192:193], v[192:193], v[194:195]
    v_cvt_pk_bf16_f32 v192, v192, v193
    ds_write_b32 v7, v192
L_e2:
    ds_read_b128 v[176:179], v10
    ds_read_b128 v[180:183], v10 offset:16
    s_waitcnt lgkmcnt(1)
    v_mfma_f32_16x16x32_bf16 v[144:147], v[176:179], v[80:83], 0
    v_mfma_f32_16x16x32_bf16 v[148:151], v[176:179], v[84:87], 0
    v_mfma_f32_16x16x32_bf16 v[152:155], v[176:179], v[88:91], 0
    v_mfma_f32_16x16x32_bf16 v[156:159], v[176:179], v[92:95], 0
    v_mfma_f32_16x16x32_bf16 v[160:163], v[176:179], v[96:99], 0
    v_mfma_f32_16x16x32_bf16 v[164:167], v[176:179], v[100:103], 0
    v_mfma_f32_16x16x32_bf16 v[168:171], v[176:179], v[104:107], 0
    v_mfma_f32_16x16x32_bf16 v[172:175], v[176:179], v[108:111], 0
    s_waitcnt lgkmcnt(0)
    v_mfma_f32_16x16x32_bf16 v[144:147], v[180:183], v[112:115], v[144:147]
    v_mfma_f32_16x16x32_bf16 v[148:151], v[180:183], v[116:119], v[148:151]
    v_mfma_f32_16x16x32_bf16 v[152:155], v[180:183], v[120:123], v[152:155]
    v_mfma_f32_16x16x32_bf16 v[156:159], v[180:183], v[124:127], v[156:159]
    v_mfma_f32_16x16x32_bf16 v[160:163], v[180:183], v[128:131], v[160:163]
    v_mfma_f32_16x16x32_bf16 v[164:167], v[180:183], v[132:135], v[164:167]
    v_mfma_f32_16x16x32_bf16 v[168:171], v[180:183], v[136:139], v[168:171]
    v_mfma_f32_16x16x32_bf16 v[172:175], v[180:183], v[140:143], v[172:175]
    s_nop 4
    v_cndmask_b32 v12, v144, v160, s[60:61]
    v_cndmask_b32 v13, v148, v164, s[60:61]
    v_cndmask_b32 v14, v152, v168, s[60:61]
    v_cndmask_b32 v15, v156, v172, s[60:61]
    v_and_or_b32 v12, v12, s64, v3
    v_and_or_b32 v13, v13, s64, v3
    v_and_or_b32 v14, v14, s64, v3
    v_and_or_b32 v15, v15, s64, v3
    buffer_store_dwordx4 v[12:15], v2, s[40:43], s56 offen sc1
    s_waitcnt vmcnt(0)
L_endE2:
    s_mov_b64 exec, 1
    v_mov_b32 v4, 0
    v_mov_b32 v5, 1
    ds_add_u32 v4, v5 offset:4376
    s_mov_b64 exec, -1
L_endE:
    s_endpgm
L_fin:
    s_lshl_b32 s52, s32, 5
    s_add_u32 s37, s52, s31
    s_cmp_ge_u32 s37, 80
    s_cbranch_scc1 L_endF
    s_lshr_b32 s38, s37, 4
    s_and_b32 s39, s37, 15
    s_bfe_u32 s52, s39, 0x10002
    s_mul_i32 s52, s52, 640
    s_lshl_b32 s53, s38, 7
    s_add_u32 s52, s52, s53
    s_and_b32 s53, s39, 3
    s_lshl_b32 s53, s53, 5
    s_add_u32 s52, s52, s53
    s_lshr_b32 s53, s39, 3
    s_lshl_b32 s53, s53, 2
    s_add_u32 s52, s52, s53
    v_and_b32 v4, 3, v1
    v_lshrrev_b32 v5, 4, v1
    v_lshl_add_u32 v10, v4, 3, v5
    v_add_lshl_u32 v10, v10, s52, 1
    buffer_load_ushort v11, v10, s[48:51], 0 offen
    v_lshrrev_b32 v5, 2, v1
    v_lshlrev_b32 v5, 10, v5
    v_lshl_add_u32 v5, v4, 4, v5
    s_lshl_b32 s58, s39, 6
    s_lshl_b32 s56, s38, 15
    s_add_u32 s56, s56, s58
    s_add_u32 s56, s56, 2162688
    s_add_u32 s57, s56, 16384
    s_lshl_b32 s52, s38, 16
    s_add_u32 s52, s52, s58
    s_add_u32 s52, s52, 1835008
    s_add_u32 s53, s52, 16384
    s_add_u32 s54, s53, 16384
    s_add_u32 s55, s54, 16384
    s_mov_b32 s44, s24
    s_mov_b32 s45, s25
    s_mov_b32 s46, 2560
    s_mov_b32 s47, 0x00020000
    v_mov_b32 v9, v5
    s_mov_b32 s59, s52
    v_mov_b32 v4, 0
Lw_recurrent_sc_28:
    ds_read_b32 v5, v4 offset:4376
    s_waitcnt lgkmcnt(0)
    v_readfirstlane_b32 s52, v5
    s_cmp_ge_u32 s52, 2
    s_cbranch_scc0 Lw_recurrent_sc_28
    s_mov_b32 s52, s59
    s_mov_b32 s66, 262144
    s_nop 0
    buffer_load_dwordx4 v[16:19], v9, s[40:43], s52 offen sc1
    buffer_load_dwordx4 v[20:23], v9, s[40:43], s53 offen sc1
    buffer_load_dwordx4 v[24:27], v9, s[40:43], s54 offen sc1
    buffer_load_dwordx4 v[28:31], v9, s[40:43], s55 offen sc1
    v_mov_b32 v36, v3
    v_mov_b32 v37, v3
    v_mov_b32 v38, v3
    v_mov_b32 v39, v3
    buffer_load_dwordx4 v[32:35], v9, s[40:43], s56 offen sc1
    s_mov_b64 s[70:71], exec
    s_and_b32 exec_hi, exec_hi, 4095
    buffer_load_dwordx4 v[36:39], v9, s[40:43], s57 offen sc1
    s_mov_b64 exec, s[70:71]
Lp_recurrent_sc_29:
    s_waitcnt vmcnt(5)
    v_xor_b32 v16, s68, v16
    v_xor_b32 v17, s68, v17
    v_xor_b32 v18, s68, v18
    v_xor_b32 v19, s68, v19
    v_or3_b32 v4, v16, v17, v18
    v_or_b32 v4, v4, v19
    s_waitcnt vmcnt(4)
    v_xor_b32 v20, s68, v20
    v_xor_b32 v21, s68, v21
    v_xor_b32 v22, s68, v22
    v_xor_b32 v23, s68, v23
    v_or3_b32 v4, v4, v20, v21
    v_or3_b32 v4, v4, v22, v23
    s_waitcnt vmcnt(3)
    v_xor_b32 v24, s68, v24
    v_xor_b32 v25, s68, v25
    v_xor_b32 v26, s68, v26
    v_xor_b32 v27, s68, v27
    v_or3_b32 v4, v4, v24, v25
    v_or3_b32 v4, v4, v26, v27
    s_waitcnt vmcnt(2)
    v_xor_b32 v28, s68, v28
    v_xor_b32 v29, s68, v29
    v_xor_b32 v30, s68, v30
    v_xor_b32 v31, s68, v31
    v_or3_b32 v4, v4, v28, v29
    v_or3_b32 v4, v4, v30, v31
    s_waitcnt vmcnt(1)
    v_xor_b32 v32, s68, v32
    v_xor_b32 v33, s68, v33
    v_xor_b32 v34, s68, v34
    v_xor_b32 v35, s68, v35
    v_or3_b32 v4, v4, v32, v33
    v_or3_b32 v4, v4, v34, v35
    s_waitcnt vmcnt(0)
    v_xor_b32 v36, s68, v36
    v_xor_b32 v37, s68, v37
    v_xor_b32 v38, s68, v38
    v_xor_b32 v39, s68, v39
    v_or3_b32 v4, v4, v36, v37
    v_or3_b32 v4, v4, v38, v39
    v_and_b32 v4, 255, v4
    v_cmp_ne_u32 vcc, 0, v4
    s_and_b64 exec, exec, vcc
    s_cbranch_scc0 Ld_recurrent_sc_30
    s_sub_u32 s66, s66, 1
    s_cbranch_scc1 Ld_recurrent_sc_30
    buffer_load_dwordx4 v[16:19], v9, s[40:43], s52 offen sc1
    buffer_load_dwordx4 v[20:23], v9, s[40:43], s53 offen sc1
    buffer_load_dwordx4 v[24:27], v9, s[40:43], s54 offen sc1
    buffer_load_dwordx4 v[28:31], v9, s[40:43], s55 offen sc1
    v_mov_b32 v36, v3
    v_mov_b32 v37, v3
    v_mov_b32 v38, v3
    v_mov_b32 v39, v3
    buffer_load_dwordx4 v[32:35], v9, s[40:43], s56 offen sc1
    s_mov_b64 s[70:71], exec
    s_and_b32 exec_hi, exec_hi, 4095
    buffer_load_dwordx4 v[36:39], v9, s[40:43], s57 offen sc1
    s_mov_b64 exec, s[70:71]
    s_branch Lp_recurrent_sc_29
Ld_recurrent_sc_30:
    s_mov_b64 exec, -1
    v_pk_add_f32 v[32:33], v[32:33], v[36:37]
    v_pk_add_f32 v[34:35], v[34:35], v[38:39]
    v_pk_add_f32 v[16:17], v[16:17], v[24:25]
    v_pk_add_f32 v[18:19], v[18:19], v[26:27]
    v_pk_add_f32 v[20:21], v[20:21], v[28:29]
    v_pk_add_f32 v[22:23], v[22:23], v[30:31]
    v_pk_add_f32 v[16:17], v[16:17], v[20:21]
    v_pk_add_f32 v[18:19], v[18:19], v[22:23]
    v_permlane32_swap_b32 v32, v34
    v_permlane32_swap_b32 v33, v35
    v_permlane32_swap_b32 v16, v18
    v_permlane32_swap_b32 v17, v19
    v_pk_add_f32 v[32:33], v[32:33], v[34:35]
    v_pk_add_f32 v[16:17], v[16:17], v[18:19]
    s_nop 0
    v_permlane16_swap_b32 v32, v33
    v_permlane16_swap_b32 v16, v17
    v_add_f32 v32, v32, v33
    v_add_f32 v16, v16, v17
    s_nop 0
    v_add_f32_dpp v32, v32, v32 row_ror:8 row_mask:0xf bank_mask:0xf
    v_add_f32_dpp v16, v16, v16 row_ror:8 row_mask:0xf bank_mask:0xf
    s_nop 0
    v_add_f32_dpp v32, v32, v32 row_ror:4 row_mask:0xf bank_mask:0xf
    v_add_f32_dpp v16, v16, v16 row_ror:4 row_mask:0xf bank_mask:0xf
    v_cvt_pk_bf16_f32 v32, v32, v32
    v_and_b32 v32, s65, v32
    v_mul_f32 v33, 0xbfb8aa3b, v32
    v_exp_f32 v33, v33
    v_cvt_pk_bf16_f32 v16, v16, v16
    v_and_b32 v16, s65, v16
    v_add_f32 v33, 1.0, v33
    v_rcp_f32 v33, v33
    v_lshlrev_b32 v11, 16, v11
    v_mul_f32 v32, v32, v33
    v_cvt_pk_bf16_f32 v32, v32, v32
    v_and_b32 v32, s65, v32
    v_mul_f32 v16, v16, v32
    v_cvt_pk_bf16_f32 v16, v16, v16
    v_and_b32 v16, s65, v16
    v_add_f32 v16, v16, v11
    v_cvt_pk_bf16_f32 v16, v16, v16
    s_mov_b32 exec_lo, 0x000f000f
    s_mov_b32 exec_hi, 0x000f000f
    buffer_store_short v16, v10, s[44:47], 0 offen
    s_cmp_eq_u32 s37, 0
    s_cbranch_scc0 L_endF
    s_mov_b64 exec, 1
    v_mov_b32 v4, s30
    v_mov_b32 v5, 0
    buffer_store_dword v4, v5, s[40:43], 0 offen sc1
L_endF:
    s_endpgm
L_tw:
    s_mov_b32 s44, s6
    s_mov_b32 s45, s7
    s_mov_b32 s46, 16777216
    s_mov_b32 s47, 0x00020000
    s_lshl_b32 s52, s33, 17
    s_lshl_b32 s53, s3, 15
    s_add_u32 s56, s52, s53
    s_mul_i32 s53, s3, 33792
    s_add_u32 s53, s53, 23040
    s_mov_b32 m0, s53
    v_and_b32 v4, 15, v1
    v_mul_u32_u24 v6, 1056, v4
    v_and_b32 v5, 48, v1
    v_add_u32 v7, v6, v5
    v_add_u32 v6, s53, v7
    v_lshlrev_b32 v8, 2, v4
    v_lshrrev_b32 v4, 2, v1
    v_mul_u32_u24 v9, 1056, v4
    v_and_b32 v4, 3, v1
    v_lshl_add_u32 v9, v4, 3, v9
    s_lshl_b32 s54, s3, 7
    s_add_u32 s54, s54, 23040
    v_add_u32 v9, s54, v9
    v_add_u32 v10, 67584, v9
    v_and_b32 v4, 15, v1
    v_lshlrev_b32 v4, 3, v4
    v_lshrrev_b32 v13, 4, v1
    v_lshl_add_u32 v13, v13, 19, v4
    s_lshl_b32 s52, s34, 21
    s_lshl_b32 s54, s3, 14
    s_add_u32 s52, s52, s54
    s_lshl_b32 s54, s33, 7
    s_add_u32 s52, s52, s54
    s_add_u32 s39, s52, 3145728
    s_lshl_b32 s54, s3, 10
    v_add_u32 v12, s54, v2
    s_movk_i32 s57, 1056
    s_movk_i32 s58, 1024
    s_waitcnt lgkmcnt(0)
    s_add_u32 s30, s30, 1
    s_and_b32 s68, s30, 0xff
    s_and_b32 s67, s30, 0x00010001
    v_mov_b32 v3, s68
    v_mov_b32 v4, 0
Lw_recurrent_sc_31:
    s_sleep 1
    ds_read_b32 v5, v4 offset:4364
    s_waitcnt lgkmcnt(0)
    v_readfirstlane_b32 s52, v5
    s_cmp_ge_u32 s52, 1
    s_cbranch_scc0 Lw_recurrent_sc_31
    buffer_load_dwordx4 v2, s[44:47], s56 offen nt lds
    s_add_u32 m0, m0, s57
    s_add_u32 s56, s56, s58
    buffer_load_dwordx4 v2, s[44:47], s56 offen nt lds
    s_add_u32 m0, m0, s57
    s_add_u32 s56, s56, s58
    buffer_load_dwordx4 v2, s[44:47], s56 offen nt lds
    s_add_u32 m0, m0, s57
    s_add_u32 s56, s56, s58
    buffer_load_dwordx4 v2, s[44:47], s56 offen nt lds
    s_add_u32 m0, m0, s57
    s_add_u32 s56, s56, s58
    buffer_load_dwordx4 v2, s[44:47], s56 offen nt lds
    s_add_u32 m0, m0, s57
    s_add_u32 s56, s56, s58
    buffer_load_dwordx4 v2, s[44:47], s56 offen nt lds
    s_add_u32 m0, m0, s57
    s_add_u32 s56, s56, s58
    buffer_load_dwordx4 v2, s[44:47], s56 offen nt lds
    s_add_u32 m0, m0, s57
    s_add_u32 s56, s56, s58
    buffer_load_dwordx4 v2, s[44:47], s56 offen nt lds
    s_add_u32 m0, m0, s57
    s_add_u32 s56, s56, s58
    s_waitcnt vmcnt(7)
    buffer_load_dwordx4 v2, s[44:47], s56 offen nt lds
    s_add_u32 m0, m0, s57
    s_add_u32 s56, s56, s58
    s_waitcnt vmcnt(7)
    buffer_load_dwordx4 v2, s[44:47], s56 offen nt lds
    s_add_u32 m0, m0, s57
    s_add_u32 s56, s56, s58
    s_waitcnt vmcnt(7)
    buffer_load_dwordx4 v2, s[44:47], s56 offen nt lds
    s_add_u32 m0, m0, s57
    s_add_u32 s56, s56, s58
    s_waitcnt vmcnt(7)
    buffer_load_dwordx4 v2, s[44:47], s56 offen nt lds
    s_add_u32 m0, m0, s57
    s_add_u32 s56, s56, s58
    s_waitcnt vmcnt(7)
    buffer_load_dwordx4 v2, s[44:47], s56 offen nt lds
    s_add_u32 m0, m0, s57
    s_add_u32 s56, s56, s58
    s_waitcnt vmcnt(7)
    buffer_load_dwordx4 v2, s[44:47], s56 offen nt lds
    s_add_u32 m0, m0, s57
    s_add_u32 s56, s56, s58
    s_waitcnt vmcnt(7)
    buffer_load_dwordx4 v2, s[44:47], s56 offen nt lds
    s_add_u32 m0, m0, s57
    s_add_u32 s56, s56, s58
    s_waitcnt vmcnt(7)
    buffer_load_dwordx4 v2, s[44:47], s56 offen nt lds
    s_add_u32 m0, m0, s57
    s_add_u32 s56, s56, s58
    s_waitcnt vmcnt(7)
    buffer_load_dwordx4 v2, s[44:47], s56 offen nt lds
    s_add_u32 m0, m0, s57
    s_add_u32 s56, s56, s58
    s_waitcnt vmcnt(7)
    buffer_load_dwordx4 v2, s[44:47], s56 offen nt lds
    s_add_u32 m0, m0, s57
    s_add_u32 s56, s56, s58
    s_waitcnt vmcnt(7)
    buffer_load_dwordx4 v2, s[44:47], s56 offen nt lds
    s_add_u32 m0, m0, s57
    s_add_u32 s56, s56, s58
    s_waitcnt vmcnt(7)
    buffer_load_dwordx4 v2, s[44:47], s56 offen nt lds
    s_add_u32 m0, m0, s57
    s_add_u32 s56, s56, s58
    s_waitcnt vmcnt(7)
    buffer_load_dwordx4 v2, s[44:47], s56 offen nt lds
    s_add_u32 m0, m0, s57
    s_add_u32 s56, s56, s58
    s_waitcnt vmcnt(7)
    buffer_load_dwordx4 v2, s[44:47], s56 offen nt lds
    s_add_u32 m0, m0, s57
    s_add_u32 s56, s56, s58
    s_waitcnt vmcnt(7)
    buffer_load_dwordx4 v2, s[44:47], s56 offen nt lds
    s_add_u32 m0, m0, s57
    s_add_u32 s56, s56, s58
    s_waitcnt vmcnt(7)
    s_cmp_eq_u32 s3, 0
    s_cbranch_scc0 Lb_recurrent_sc_32
    s_mov_b64 exec, 1
    v_mov_b32 v4, 0
    v_mov_b32 v5, 1
    ds_add_u32 v4, v5 offset:4356
    s_mov_b64 exec, -1
Lb_recurrent_sc_32:
    buffer_load_dwordx4 v2, s[44:47], s56 offen nt lds
    s_add_u32 m0, m0, s57
    s_add_u32 s56, s56, s58
    s_waitcnt vmcnt(7)
    buffer_load_dwordx4 v2, s[44:47], s56 offen nt lds
    s_add_u32 m0, m0, s57
    s_add_u32 s56, s56, s58
    s_waitcnt vmcnt(7)
    buffer_load_dwordx4 v2, s[44:47], s56 offen nt lds
    s_add_u32 m0, m0, s57
    s_add_u32 s56, s56, s58
    s_waitcnt vmcnt(7)
    buffer_load_dwordx4 v2, s[44:47], s56 offen nt lds
    s_add_u32 m0, m0, s57
    s_add_u32 s56, s56, s58
    s_waitcnt vmcnt(7)
    buffer_load_dwordx4 v2, s[44:47], s56 offen nt lds
    s_add_u32 m0, m0, s57
    s_add_u32 s56, s56, s58
    s_waitcnt vmcnt(7)
    buffer_load_dwordx4 v2, s[44:47], s56 offen nt lds
    s_add_u32 m0, m0, s57
    s_add_u32 s56, s56, s58
    s_waitcnt vmcnt(7)
    buffer_load_dwordx4 v2, s[44:47], s56 offen nt lds
    s_add_u32 m0, m0, s57
    s_add_u32 s56, s56, s58
    s_waitcnt vmcnt(7)
    buffer_load_dwordx4 v2, s[44:47], s56 offen nt lds
    s_add_u32 m0, m0, s57
    s_add_u32 s56, s56, s58
    s_waitcnt vmcnt(7)
    buffer_load_dwordx4 v2, s[44:47], s56 offen nt lds
    s_barrier
    ds_read_b128 v[16:19], v7 offset:6144
    ds_read_b128 v[20:23], v7 offset:6208
    ds_read_b128 v[24:27], v7 offset:6272
    ds_read_b128 v[28:31], v7 offset:6336
    ds_read_b128 v[32:35], v7 offset:6400
    ds_read_b128 v[36:39], v7 offset:6464
    ds_read_b128 v[40:43], v7 offset:6528
    ds_read_b128 v[44:47], v7 offset:6592
    ds_read_b128 v[48:51], v7 offset:6656
    ds_read_b128 v[52:55], v7 offset:6720
    ds_read_b128 v[56:59], v7 offset:6784
    ds_read_b128 v[60:63], v7 offset:6848
    s_waitcnt lgkmcnt(4)
    ds_read_b128 v[64:67], v7 offset:6912
    ds_read_b128 v[68:71], v7 offset:6976
    ds_read_b128 v[72:75], v7 offset:7040
    ds_read_b128 v[76:79], v7 offset:7104
    s_waitcnt lgkmcnt(6)
    ds_read_b128 v[80:83], v6 offset:0
    ds_read_b128 v[84:87], v6 offset:64
    ds_read_b128 v[88:91], v6 offset:128
    ds_read_b128 v[92:95], v6 offset:192
    ds_read_b128 v[96:99], v6 offset:256
    ds_read_b128 v[100:103], v6 offset:320
    ds_read_b128 v[104:107], v6 offset:384
    ds_read_b128 v[108:111], v6 offset:448
    s_waitcnt lgkmcnt(7)
    v_mfma_f32_16x16x32_bf16 v[240:243], v[80:83], v[16:19], 0
    ds_read_b128 v[112:115], v6 offset:512
    s_waitcnt lgkmcnt(7)
    v_mfma_f32_16x16x32_bf16 v[240:243], v[84:87], v[20:23], v[240:243]
    ds_read_b128 v[116:119], v6 offset:576
    s_waitcnt lgkmcnt(7)
    v_mfma_f32_16x16x32_bf16 v[240:243], v[88:91], v[24:27], v[240:243]
    ds_read_b128 v[120:123], v6 offset:640
    s_waitcnt lgkmcnt(7)
    v_mfma_f32_16x16x32_bf16 v[240:243], v[92:95], v[28:31], v[240:243]
    ds_read_b128 v[124:127], v6 offset:704
    s_waitcnt lgkmcnt(7)
    v_mfma_f32_16x16x32_bf16 v[240:243], v[96:99], v[32:35], v[240:243]
    ds_read_b128 v[128:131], v6 offset:768
    s_waitcnt lgkmcnt(7)
    v_mfma_f32_16x16x32_bf16 v[240:243], v[100:103], v[36:39], v[240:243]
    ds_read_b128 v[132:135], v6 offset:832
    s_waitcnt lgkmcnt(7)
    v_mfma_f32_16x16x32_bf16 v[240:243], v[104:107], v[40:43], v[240:243]
    ds_read_b128 v[136:139], v6 offset:896
    s_waitcnt lgkmcnt(7)
    v_mfma_f32_16x16x32_bf16 v[240:243], v[108:111], v[44:47], v[240:243]
    ds_read_b128 v[140:143], v6 offset:960
    s_waitcnt lgkmcnt(7)
    v_mfma_f32_16x16x32_bf16 v[240:243], v[112:115], v[48:51], v[240:243]
    s_waitcnt lgkmcnt(6)
    v_mfma_f32_16x16x32_bf16 v[240:243], v[116:119], v[52:55], v[240:243]
    s_waitcnt lgkmcnt(5)
    v_mfma_f32_16x16x32_bf16 v[240:243], v[120:123], v[56:59], v[240:243]
    s_waitcnt lgkmcnt(4)
    v_mfma_f32_16x16x32_bf16 v[240:243], v[124:127], v[60:63], v[240:243]
    s_waitcnt lgkmcnt(3)
    v_mfma_f32_16x16x32_bf16 v[240:243], v[128:131], v[64:67], v[240:243]
    s_waitcnt lgkmcnt(2)
    v_mfma_f32_16x16x32_bf16 v[240:243], v[132:135], v[68:71], v[240:243]
    s_waitcnt lgkmcnt(1)
    v_mfma_f32_16x16x32_bf16 v[240:243], v[136:139], v[72:75], v[240:243]
    s_waitcnt lgkmcnt(0)
    v_mfma_f32_16x16x32_bf16 v[240:243], v[140:143], v[76:79], v[240:243]
    ds_read_b64_tr_b16 v[144:145], v9 offset:0
    ds_read_b64_tr_b16 v[148:149], v9 offset:33792
    ds_read_b64_tr_b16 v[152:153], v10 offset:0
    ds_read_b64_tr_b16 v[156:157], v10 offset:33792
    ds_read_b64_tr_b16 v[160:161], v9 offset:32
    ds_read_b64_tr_b16 v[164:165], v9 offset:33824
    ds_read_b64_tr_b16 v[168:169], v10 offset:32
    ds_read_b64_tr_b16 v[172:173], v10 offset:33824
    ds_read_b64_tr_b16 v[176:177], v9 offset:64
    ds_read_b64_tr_b16 v[180:181], v9 offset:33856
    ds_read_b64_tr_b16 v[184:185], v10 offset:64
    ds_read_b64_tr_b16 v[188:189], v10 offset:33856
    s_waitcnt lgkmcnt(8)
    ds_read_b64_tr_b16 v[192:193], v9 offset:96
    ds_read_b64_tr_b16 v[196:197], v9 offset:33888
    ds_read_b64_tr_b16 v[200:201], v10 offset:96
    ds_read_b64_tr_b16 v[204:205], v10 offset:33888
    s_waitcnt vmcnt(0) lgkmcnt(3)
    ds_read_b128 v[80:83], v6 offset:16896
    ds_read_b128 v[84:87], v6 offset:16960
    ds_read_b128 v[88:91], v6 offset:17024
    ds_read_b128 v[92:95], v6 offset:17088
    ds_read_b128 v[96:99], v6 offset:17152
    ds_read_b128 v[100:103], v6 offset:17216
    ds_read_b128 v[104:107], v6 offset:17280
    ds_read_b128 v[108:111], v6 offset:17344
    ds_read_b128 v[112:115], v6 offset:17408
    ds_read_b128 v[116:119], v6 offset:17472
    ds_read_b128 v[120:123], v6 offset:17536
    ds_read_b128 v[124:127], v6 offset:17600
    s_waitcnt lgkmcnt(11)
    v_mfma_f32_16x16x32_bf16 v[244:247], v[80:83], v[16:19], 0
    ds_read_b128 v[128:131], v6 offset:17664
    s_waitcnt lgkmcnt(11)
    v_mfma_f32_16x16x32_bf16 v[244:247], v[84:87], v[20:23], v[244:247]
    ds_read_b128 v[132:135], v6 offset:17728
    s_waitcnt lgkmcnt(11)
    v_mfma_f32_16x16x32_bf16 v[244:247], v[88:91], v[24:27], v[244:247]
    ds_read_b128 v[136:139], v6 offset:17792
    s_waitcnt lgkmcnt(11)
    v_mfma_f32_16x16x32_bf16 v[244:247], v[92:95], v[28:31], v[244:247]
    ds_read_b128 v[140:143], v6 offset:17856
    s_waitcnt lgkmcnt(11)
    v_mfma_f32_16x16x32_bf16 v[244:247], v[96:99], v[32:35], v[244:247]
    s_waitcnt lgkmcnt(10)
    v_mfma_f32_16x16x32_bf16 v[244:247], v[100:103], v[36:39], v[244:247]
    s_waitcnt lgkmcnt(9)
    v_mfma_f32_16x16x32_bf16 v[244:247], v[104:107], v[40:43], v[244:247]
    s_waitcnt lgkmcnt(8)
    v_mfma_f32_16x16x32_bf16 v[244:247], v[108:111], v[44:47], v[244:247]
    s_waitcnt lgkmcnt(7)
    v_mfma_f32_16x16x32_bf16 v[244:247], v[112:115], v[48:51], v[244:247]
    s_waitcnt lgkmcnt(6)
    v_mfma_f32_16x16x32_bf16 v[244:247], v[116:119], v[52:55], v[244:247]
    s_waitcnt lgkmcnt(5)
    v_mfma_f32_16x16x32_bf16 v[244:247], v[120:123], v[56:59], v[244:247]
    s_waitcnt lgkmcnt(4)
    v_mfma_f32_16x16x32_bf16 v[244:247], v[124:127], v[60:63], v[244:247]
    s_waitcnt lgkmcnt(3)
    v_mfma_f32_16x16x32_bf16 v[244:247], v[128:131], v[64:67], v[244:247]
    s_waitcnt lgkmcnt(2)
    v_mfma_f32_16x16x32_bf16 v[244:247], v[132:135], v[68:71], v[244:247]
    s_waitcnt lgkmcnt(1)
    v_mfma_f32_16x16x32_bf16 v[244:247], v[136:139], v[72:75], v[244:247]
    s_waitcnt lgkmcnt(0)
    v_mfma_f32_16x16x32_bf16 v[244:247], v[140:143], v[76:79], v[244:247]
    v_max3_f32 v4, v240, v241, v242
    v_max_f32 v4, v4, v243
    s_mov_b32 s54, 0x3e0293ee
    s_nop 4
    v_max3_f32 v4, v4, v244, v245
    v_max3_f32 v4, v4, v246, v247
    ds_max_f32 v8, v4 offset:4096
    s_waitcnt lgkmcnt(0)
    s_barrier
    ds_read_b32 v4, v8 offset:4096
    ds_read_b64_tr_b16 v[146:147], v9 offset:16896
    ds_read_b64_tr_b16 v[150:151], v9 offset:50688
    ds_read_b64_tr_b16 v[154:155], v10 offset:16896
    ds_read_b64_tr_b16 v[158:159], v10 offset:50688
    ds_read_b64_tr_b16 v[162:163], v9 offset:16928
    ds_read_b64_tr_b16 v[166:167], v9 offset:50720
    ds_read_b64_tr_b16 v[170:171], v10 offset:16928
    ds_read_b64_tr_b16 v[174:175], v10 offset:50720
    ds_read_b64_tr_b16 v[178:179], v9 offset:16960
    ds_read_b64_tr_b16 v[182:183], v9 offset:50752
    ds_read_b64_tr_b16 v[186:187], v10 offset:16960
    ds_read_b64_tr_b16 v[190:191], v10 offset:50752
    s_waitcnt lgkmcnt(12)
    v_mul_f32 v4, s54, v4
    v_fma_f32 v240, v240, s54, -v4
    v_fma_f32 v241, v241, s54, -v4
    v_fma_f32 v242, v242, s54, -v4
    v_fma_f32 v243, v243, s54, -v4
    v_fma_f32 v244, v244, s54, -v4
    v_fma_f32 v245, v245, s54, -v4
    v_fma_f32 v246, v246, s54, -v4
    v_fma_f32 v247, v247, s54, -v4
    v_exp_f32 v240, v240
    v_exp_f32 v241, v241
    v_exp_f32 v242, v242
    v_exp_f32 v243, v243
    v_exp_f32 v244, v244
    v_exp_f32 v245, v245
    v_exp_f32 v246, v246
    v_exp_f32 v247, v247
    v_cvt_pk_bf16_f32 v240, v240, v241
    v_cvt_pk_bf16_f32 v241, v242, v243
    v_cvt_pk_bf16_f32 v242, v244, v245
    v_cvt_pk_bf16_f32 v243, v246, v247
    s_waitcnt lgkmcnt(8)
    ds_write_b128 v12, v[240:243] offset:0
    ds_read_b64_tr_b16 v[194:195], v9 offset:16992
    ds_read_b64_tr_b16 v[198:199], v9 offset:50784
    ds_read_b64_tr_b16 v[202:203], v10 offset:16992
    ds_read_b64_tr_b16 v[206:207], v10 offset:50784
    s_waitcnt lgkmcnt(4)
    s_branch L_bar3
L_exit:
    s_endpgm
L_codeend:
.section .rodata,"a"
.p2align 6
.amdhsa_kernel recurrent_scan__compressed_kv_cla__geglu_ffn__decode_kernel
  .amdhsa_next_free_vgpr 256
  .amdhsa_next_free_sgpr 102
  .amdhsa_accum_offset 256
  .amdhsa_group_segment_fixed_size 0
  .amdhsa_kernarg_size 104
  .amdhsa_user_sgpr_count 2
  .amdhsa_user_sgpr_kernarg_segment_ptr 1
  .amdhsa_system_sgpr_workgroup_id_x 1
  .amdhsa_float_denorm_mode_32 3
.end_amdhsa_kernel
```
